```python
import torch

def _softmax(x, axis=-1):
    return torch.softmax(x, dim=axis)
def _gelu(x):
    return torch.nn.functional.gelu(x, approximate="tanh")
def _silu(x):
    return torch.nn.functional.silu(x)
def _sigmoid(x):
    return torch.sigmoid(x)
def _layernorm(x, axis=-1, eps=1e-5):
    m = x.mean(dim=axis, keepdim=True)
    v = x.var(dim=axis, keepdim=True, unbiased=False)
    return (x - m) / torch.sqrt(v + eps)
def _scatter_add(tgt, idx, src, axis=0):
    return tgt.clone().index_add_(axis, idx, src)
def _segment_sum(src, seg, n):
    out = torch.zeros((n,) + src.shape[1:], dtype=src.dtype)
    return out.index_add_(0, seg, src)
def _pad(x, pw):
    flat = tuple(v for pair in reversed(pw) for v in pair)
    return torch.nn.functional.pad(x, flat)

kernel_name = 'gated_mix__mha_block__sliding_block__prompt'

def setup_inputs():

    _w = (lambda a: (lambda t: t.to(torch.bfloat16) if t.is_floating_point() else t)(torch.as_tensor(a)))
    def _A_setup():
        B, S, D, H = 1, 2048, 512, 32
        return {
            "x": _w((lambda *s: torch.randn(*s, dtype=torch.bfloat16) * 0.05)(B, S, D)),
            "wqkv": _w((lambda *s: torch.randn(*s, dtype=torch.bfloat16) * 1.6)(D, 3 * D)),
            "wo": _w((lambda *s: torch.randn(*s, dtype=torch.bfloat16) * 0.1)(D, D)),
        }
    _A_in = _A_setup()

    def _B_setup():
        B, S, D = 1, 2048, 512
        return {
            "x": _w((lambda *s: torch.randn(*s, dtype=torch.bfloat16) * 0.05)(B, S, D)),
            "wqkv": _w((lambda *s: torch.randn(*s, dtype=torch.bfloat16) * 1.6)(D, 3 * D)),
            "wo": _w((lambda *s: torch.randn(*s, dtype=torch.bfloat16) * 0.05)(D, D)),
        }
    _B_in = _B_setup()

    return {
        "A_x": _A_in["x"],
        "A_wqkv": _A_in["wqkv"],
        "A_wo": _A_in["wo"],
        "B_x": _B_in["x"],
        "B_wqkv": _B_in["wqkv"],
        "B_wo": _B_in["wo"],
        "gate_w": _w((lambda *s: torch.randn(*s, dtype=torch.bfloat16) * 0.05)(512) * 16.0),
    }

def reference(A_x, A_wqkv, A_wo, B_x, B_wqkv, B_wo, gate_w):
    def _A_ref(x, wqkv, wo):
        B, S, D = x.shape
        H = 32
        Dh = D // H
        qkv = (lambda x, *d: x.permute(*d))((x @ wqkv).reshape(B, S, 3, H, Dh), 2, 0, 3, 1, 4)
        q, k, v = qkv[0], qkv[1], qkv[2]
        scores = torch.einsum("bhqd,bhkd->bhqk", q, k) * (Dh ** -0.5)
        p = _softmax(scores, axis=-1)
        o = torch.einsum("bhqk,bhkd->bhqd", p, v)
        return (lambda x, *d: x.permute(*d))(o, 0, 2, 1, 3).reshape(B, S, D) @ wo

    def _B_ref(x, wqkv, wo):
        B, S, D = x.shape
        H = 32; Dh = D // H; W = 256
        qkv = (lambda x, *d: x.permute(*d))((x @ wqkv).reshape(B, S, 3, H, Dh), 2, 0, 3, 1, 4)
        q, k, v = qkv[0], qkv[1], qkv[2]
        scores = torch.einsum("bhqd,bhkd->bhqk", q, k) * (Dh ** -0.5)
        idx = torch.arange(S)
        mask = (idx[:, None] - idx[None, :] >= 0) & (idx[:, None] - idx[None, :] < W)
        scores = torch.where(mask[None, None], scores, -1e9)
        p = _softmax(scores, axis=-1)
        o = torch.einsum("bhqk,bhkd->bhqd", p, v)
        return (lambda x, *d: x.permute(*d))(o, 0, 2, 1, 3).reshape(B, S, D) @ wo

    x = A_x
    g = _sigmoid((x * gate_w).sum(-1, keepdims=True))
    a = _A_ref(x, A_wqkv, A_wo)
    b = _B_ref(x, B_wqkv, B_wo)
    return g * a + (1 - g) * b
```

```asm
; @launch grid=(256,1,1) block=(512,1,1) lds=163840
.amdgcn_target "amdgcn-amd-amdhsa--gfx950"
.text
.globl gated_mix__mha_block__sliding_block__prompt_kernel
.p2align 8
.type gated_mix__mha_block__sliding_block__prompt_kernel,@function
gated_mix__mha_block__sliding_block__prompt_kernel:
    s_cmp_ge_u32 s2, 256
    s_cbranch_scc1 L_end
    s_load_dwordx16 s[32:47], s[0:1], 0
    s_load_dwordx4 s[48:51], s[0:1], 64
    v_lshrrev_b32 v2, 6, v0
    v_and_b32 v1, 63, v0
    v_readfirstlane_b32 s52, v2
    v_lshlrev_b32 v2, 4, v1
    s_and_b32 s53, s2, 7
    s_lshr_b32 s54, s2, 3
    s_and_b32 s55, s53, 7
    s_lshl_b32 s55, s55, 0
    s_and_b32 s56, s54, 0
    s_add_u32 s55, s55, s56
    s_lshr_b32 s56, s53, 3
    s_lshl_b32 s56, s56, 4
    s_bfe_u32 s57, s54, 0x40000
    s_add_u32 s56, s56, s57
    s_lshr_b32 s57, s54, 4
    s_lshl_b32 s3, s56, 1
    s_add_u32 s3, s3, s57
    s_add_u32 s58, s55, s56
    s_lshl_b32 s58, s58, 1
    s_and_b32 s58, s58, 6
    s_mul_i32 s31, s57, 1
    s_and_b32 s68, s52, 3
    s_cmp_lg_u32 s52, 3
    s_cbranch_scc1 L_nopf
    s_getpc_b64 s[28:29]
L_pcref:
    s_lshl_b32 s59, s54, 11
    v_lshlrev_b32 v10, 7, v1
    v_add_u32 v10, s59, v10
    v_cmp_gt_u32 vcc, L_code_end-L_pcref, v10
    s_and_b64 vcc, vcc, 0xffff
    v_mov_b32 v11, s29
    s_and_saveexec_b64 s[26:27], vcc
    s_cbranch_execz L_pf_skip
    v_add_co_u32 v10, vcc, s28, v10
    s_nop 1
    v_addc_co_u32 v11, vcc, 0, v11, vcc
    global_load_dword v249, v[10:11], off
L_pf_skip:
    s_mov_b64 exec, s[26:27]
L_nopf:
    s_cmp_lt_u32 s52, 4
    s_cbranch_scc1 L_comp
    v_lshrrev_b32 v5, 3, v1
    s_lshl_b32 s59, s68, 3
    v_add_u32 v5, s59, v5
    v_and_b32 v7, 7, v1
    v_bfe_u32 v6, v5, 1, 3
    v_xor_b32 v6, v6, v7
    v_lshlrev_b32 v3, 10, v5
    v_lshl_add_u32 v3, v6, 4, v3
    s_lshl_b32 s59, s56, 17
    v_add_u32 v3, s59, v3
    v_mul_u32_u24 v4, 3072, v5
    v_bfe_u32 v6, v1, 4, 1
    v_lshlrev_b32 v6, 2, v6
    v_xor_b32 v6, v6, v7
    s_and_b32 s59, s68, 1
    s_lshl_b32 s59, s59, 1
    v_xor_b32 v6, s59, v6
    v_lshl_add_u32 v4, v6, 4, v4
    s_lshl_b32 s59, s55, 7
    v_add_u32 v4, s59, v4
    s_lshl_b32 s59, s57, 10
    s_add_u32 s59, s59, 1024
    v_add_u32 v9, s59, v4
    v_lshrrev_b32 v5, 2, v1
    s_lshl_b32 s59, s68, 4
    v_add_u32 v5, s59, v5
    v_mul_u32_u24 v4, 3072, v5
    v_and_b32 v5, 48, v2
    v_and_b32 v6, 32, v1
    v_xor_b32 v5, v5, v6
    v_add_u32 v4, v4, v5
    s_lshl_b32 s59, s55, 7
    s_lshl_b32 s60, s57, 6
    s_add_u32 s59, s59, s60
    v_add_u32 v4, s59, v4
    s_lshl_b32 s71, s68, 10
    s_mov_b32 s60, s58
    s_mov_b32 s69, s31
    s_mov_b32 s63, 0
    s_waitcnt lgkmcnt(0)
    s_mov_b32 s8, s34
    s_mov_b32 s9, s35
    s_mov_b32 s10, 0x180000
    s_mov_b32 s11, 0x00020000
    s_mov_b32 s4, s32
    s_mov_b32 s5, s33
    s_mov_b32 s6, 0x200000
    s_mov_b32 s7, 0x00020000
    s_mov_b32 s12, s40
    s_mov_b32 s13, s41
    s_mov_b32 s14, 0x180000
    s_mov_b32 s15, 0x00020000
L_ld_loop:
    s_xor_b32 s62, s60, s69
    s_lshl_b32 s61, s62, 7
    s_mul_i32 s62, s62, 196608
    s_add_u32 m0, s71, 16384
    s_add_u32 s70, s62, 0
    buffer_load_dwordx4 v9, s[8:11], s70 offen lds
    s_add_u32 m0, s71, 20480
    s_add_u32 s70, s62, 98304
    buffer_load_dwordx4 v9, s[8:11], s70 offen lds
    s_add_u32 m0, s71, 24576
    s_nop 0
    buffer_load_dwordx4 v4, s[8:11], s62 offen lds
    s_add_u32 m0, s71, 0
    s_add_u32 s70, s61, 0
    buffer_load_dwordx4 v3, s[4:7], s70 offen lds
    s_add_u32 m0, s71, 4096
    s_add_u32 s70, s61, 32768
    buffer_load_dwordx4 v3, s[4:7], s70 offen lds
    s_add_u32 m0, s71, 8192
    s_add_u32 s70, s61, 65536
    buffer_load_dwordx4 v3, s[4:7], s70 offen lds
    s_add_u32 m0, s71, 12288
    s_add_u32 s70, s61, 98304
    buffer_load_dwordx4 v3, s[4:7], s70 offen lds
    s_add_u32 s60, s60, 1
    s_and_b32 s60, s60, 7
    s_add_u32 s71, s71, 32768
    s_and_b32 s71, s71, 0x1ffff
    s_add_u32 s63, s63, 1
    s_cmp_eq_u32 s63, 1
    s_cbranch_scc1 L_ld_loop
    s_cmp_eq_u32 s63, 2
    s_cbranch_scc1 L_ld_init
L_ld_wait:
    s_waitcnt vmcnt(7)
    s_barrier
    s_cmp_eq_u32 s63, 6
    s_cbranch_scc1 L_ld_mw
L_ld_mwr:
    s_cmp_lt_u32 s63, 8
    s_cbranch_scc1 L_ld_loop
    s_mov_b32 s16, s50
    s_mov_b32 s17, s51
    s_mov_b32 s18, 0x1800000
    s_mov_b32 s19, 0x00020000
    s_mov_b32 s20, s48
    s_mov_b32 s21, s49
    s_mov_b32 s22, 0x100
    s_mov_b32 s23, 0x00020000
    s_xor_b32 s62, s60, s69
    s_mul_i32 s62, s62, 196608
    s_add_u32 m0, s71, 0
    s_add_u32 s70, s62, 0
    buffer_load_dwordx4 v9, s[12:15], s70 offen lds
    s_add_u32 m0, s71, 4096
    s_add_u32 s70, s62, 98304
    buffer_load_dwordx4 v9, s[12:15], s70 offen lds
    s_add_u32 m0, s71, 28672
    s_nop 0
    buffer_load_dwordx4 v4, s[12:15], s62 offen lds
    s_add_u32 s60, s60, 1
    s_and_b32 s60, s60, 7
    s_xor_b32 s62, s60, s69
    s_mul_i32 s62, s62, 196608
    s_add_u32 m0, s71, 8192
    s_add_u32 s70, s62, 0
    buffer_load_dwordx4 v9, s[12:15], s70 offen lds
    s_add_u32 m0, s71, 12288
    s_add_u32 s70, s62, 98304
    buffer_load_dwordx4 v9, s[12:15], s70 offen lds
    s_add_u32 m0, s71, 61440
    s_nop 0
    buffer_load_dwordx4 v4, s[12:15], s62 offen lds
    s_add_u32 s60, s60, 1
    s_and_b32 s60, s60, 7
    s_xor_b32 s62, s60, s69
    s_mul_i32 s62, s62, 196608
    s_add_u32 m0, s71, 16384
    s_add_u32 s70, s62, 0
    buffer_load_dwordx4 v9, s[12:15], s70 offen lds
    s_add_u32 m0, s71, 20480
    s_add_u32 s70, s62, 98304
    buffer_load_dwordx4 v9, s[12:15], s70 offen lds
    s_add_u32 m0, s71, 94208
    s_nop 0
    buffer_load_dwordx4 v4, s[12:15], s62 offen lds
    s_add_u32 s60, s60, 1
    s_and_b32 s60, s60, 7
    s_lshl_b32 s59, s68, 2
    s_add_u32 s59, s59, 163792
    v_mov_b32 v10, s59
    s_waitcnt vmcnt(9)
    s_barrier
    s_waitcnt lgkmcnt(0)
    v_mov_b32 v249, 0
    buffer_load_dwordx2 v[254:255], v249, s[20:23], 0 offen sc1
    v_and_b32 v12, 31, v1
    s_lshl_b32 s59, s68, 5
    v_add_u32 v12, s59, v12
    v_lshrrev_b32 v13, 1, v12
    v_lshlrev_b32 v13, 11, v13
    v_and_b32 v12, 1, v12
    v_lshl_add_u32 v12, v12, 9, v13
    s_lshl_b32 s59, s55, 17
    s_add_u32 s59, s59, 18874368
    buffer_load_dword v13, v12, s[16:19], s59 offen offset:1024 sc1
    s_waitcnt vmcnt(0)
    v_mov_b32 v11, 2
    ds_write_b32 v10, v11
    s_mov_b32 s59, 262144
L_tag_1:
    v_cmp_eq_u32 vcc, 0, v255
    s_cbranch_vccz L_tag_1_ok
    buffer_load_dwordx2 v[254:255], v249, s[20:23], 0 offen sc1
    s_waitcnt vmcnt(0)
    s_sleep 1
    s_sub_u32 s59, s59, 1
    s_cmp_lg_u32 s59, 0
    s_cbranch_scc1 L_tag_1
L_tag_1_ok:
    v_readfirstlane_b32 s30, v254
    v_readfirstlane_b32 s31, v255
    v_mov_b32 v250, 163776
    s_mov_b32 s59, 2097152
L_lw_2:
    ds_read_b32 v251, v250 offset:4
    s_waitcnt lgkmcnt(0)
    v_cmp_gt_u32 vcc, 4, v251
    s_cbranch_vccz L_lw_2_ok
    s_sleep 1
    s_sub_u32 s59, s59, 1
    s_cmp_lg_u32 s59, 0
    s_cbranch_scc1 L_lw_2
L_lw_2_ok:
    s_xor_b32 s62, s60, s69
    s_mul_i32 s62, s62, 196608
    s_add_u32 m0, s71, 32768
    s_add_u32 s70, s62, 0
    buffer_load_dwordx4 v9, s[12:15], s70 offen lds
    s_add_u32 m0, s71, 36864
    s_add_u32 s70, s62, 98304
    buffer_load_dwordx4 v9, s[12:15], s70 offen lds
    s_add_u32 m0, s71, 126976
    s_nop 0
    buffer_load_dwordx4 v4, s[12:15], s62 offen lds
    s_add_u32 s60, s60, 1
    s_and_b32 s60, s60, 7
    s_xor_b32 s62, s60, s69
    s_mul_i32 s62, s62, 196608
    s_add_u32 m0, s71, 40960
    s_add_u32 s70, s62, 0
    buffer_load_dwordx4 v9, s[12:15], s70 offen lds
    s_add_u32 m0, s71, 45056
    s_add_u32 s70, s62, 98304
    buffer_load_dwordx4 v9, s[12:15], s70 offen lds
    s_add_u32 m0, s71, 24576
    s_nop 0
    buffer_load_dwordx4 v4, s[12:15], s62 offen lds
    s_add_u32 s60, s60, 1
    s_and_b32 s60, s60, 7
    s_xor_b32 s62, s60, s69
    s_mul_i32 s62, s62, 196608
    s_add_u32 m0, s71, 49152
    s_add_u32 s70, s62, 0
    buffer_load_dwordx4 v9, s[12:15], s70 offen lds
    s_add_u32 m0, s71, 53248
    s_add_u32 s70, s62, 98304
    buffer_load_dwordx4 v9, s[12:15], s70 offen lds
    s_add_u32 m0, s71, 57344
    s_nop 0
    buffer_load_dwordx4 v4, s[12:15], s62 offen lds
    s_add_u32 s60, s60, 1
    s_and_b32 s60, s60, 7
    s_xor_b32 s62, s60, s69
    s_mul_i32 s62, s62, 196608
    s_add_u32 m0, s71, 65536
    s_add_u32 s70, s62, 0
    buffer_load_dwordx4 v9, s[12:15], s70 offen lds
    s_add_u32 m0, s71, 69632
    s_add_u32 s70, s62, 98304
    buffer_load_dwordx4 v9, s[12:15], s70 offen lds
    s_add_u32 m0, s71, 90112
    s_nop 0
    buffer_load_dwordx4 v4, s[12:15], s62 offen lds
    s_add_u32 s60, s60, 1
    s_and_b32 s60, s60, 7
    s_xor_b32 s62, s60, s69
    s_mul_i32 s62, s62, 196608
    s_add_u32 m0, s71, 73728
    s_add_u32 s70, s62, 0
    buffer_load_dwordx4 v9, s[12:15], s70 offen lds
    s_add_u32 m0, s71, 77824
    s_add_u32 s70, s62, 98304
    buffer_load_dwordx4 v9, s[12:15], s70 offen lds
    s_add_u32 m0, s71, 122880
    s_nop 0
    buffer_load_dwordx4 v4, s[12:15], s62 offen lds
    s_add_u32 s60, s60, 1
    s_and_b32 s60, s60, 7
    s_waitcnt vmcnt(6)
    v_mov_b32 v11, 3
    ds_write_b32 v10, v11
    s_branch L_p2
L_ld_mw:
    s_lshl_b32 s59, s54, 2
    s_add_u32 s59, s59, s68
    s_mul_i32 s64, s59, 12288
    s_lshl_b32 s65, s55, 7
    s_add_u32 s64, s64, s65
    s_add_u32 s28, s40, s64
    s_addc_u32 s29, s41, 0
    s_load_dword s66, s[28:29], 0
    s_load_dword s66, s[28:29], 64
    s_load_dword s66, s[28:29], 1024
    s_load_dword s66, s[28:29], 1088
    s_load_dword s66, s[28:29], 2048
    s_load_dword s66, s[28:29], 2112
    s_load_dword s66, s[28:29], 3072
    s_load_dword s66, s[28:29], 3136
    s_load_dword s66, s[28:29], 4096
    s_load_dword s66, s[28:29], 4160
    s_load_dword s66, s[28:29], 5120
    s_load_dword s66, s[28:29], 5184
    s_load_dword s66, s[28:29], 6144
    s_load_dword s66, s[28:29], 6208
    s_load_dword s66, s[28:29], 7168
    s_load_dword s66, s[28:29], 7232
    s_load_dword s66, s[28:29], 8192
    s_load_dword s66, s[28:29], 8256
    s_load_dword s66, s[28:29], 9216
    s_load_dword s66, s[28:29], 9280
    s_load_dword s66, s[28:29], 10240
    s_load_dword s66, s[28:29], 10304
    s_load_dword s66, s[28:29], 11264
    s_load_dword s66, s[28:29], 11328
    s_branch L_ld_mwr
L_ld_init:
    v_mov_b32 v92, 0
    v_mov_b32 v93, 0
    v_mov_b32 v94, 0
    v_mov_b32 v95, 0
    v_mov_b32 v146, 0xff800000
    v_mov_b32 v52, 0xdddddddd
    v_mfma_f32_32x32x16_bf16 v[60:75], v[92:95], v[92:95], 0
    v_mfma_f32_32x32x16_bf16 v[76:91], v[92:95], v[92:95], 0
    v_mfma_f32_32x32x16_bf16 v[200:215], v[92:95], v[92:95], 0
    v_mfma_f32_32x32x16_bf16 v[216:231], v[92:95], v[92:95], 0
    v_mov_b32 v196, 0
    v_mov_b32 v197, 0
    v_mov_b32 v198, 0
    v_mov_b32 v199, 0
    v_add_u32 v148, 147456, v2
    s_cmp_ge_u32 s3, 4
    s_cselect_b64 s[64:65], -1, 0
    v_cndmask_b32 v151, v146, 0, s[64:65]
    s_mov_b32 s64, 0xffffffff
    s_mov_b32 s65, 0xfffffff0
    v_cndmask_b32 v108, v146, 0, s[64:65]
    v_cndmask_b32 v124, v151, v146, s[64:65]
    s_mov_b32 s66, 0xfffffffe
    s_mov_b32 s67, 0xffffffe0
    v_cndmask_b32 v109, v146, 0, s[66:67]
    v_cndmask_b32 v125, v151, v146, s[66:67]
    s_mov_b32 s64, 0xfffffffc
    s_mov_b32 s65, 0xffffffc0
    v_cndmask_b32 v110, v146, 0, s[64:65]
    v_cndmask_b32 v126, v151, v146, s[64:65]
    s_mov_b32 s66, 0xfffffff8
    s_mov_b32 s67, 0xffffff80
    v_cndmask_b32 v111, v146, 0, s[66:67]
    v_cndmask_b32 v127, v151, v146, s[66:67]
    s_mov_b32 s64, 0xffffff00
    s_mov_b32 s65, 0xfffff000
    v_cndmask_b32 v112, v146, 0, s[64:65]
    v_cndmask_b32 v128, v151, v146, s[64:65]
    s_mov_b32 s66, 0xfffffe00
    s_mov_b32 s67, 0xffffe000
    v_cndmask_b32 v113, v146, 0, s[66:67]
    v_cndmask_b32 v129, v151, v146, s[66:67]
    s_mov_b32 s64, 0xfffffc00
    s_mov_b32 s65, 0xffffc000
    v_cndmask_b32 v114, v146, 0, s[64:65]
    v_cndmask_b32 v130, v151, v146, s[64:65]
    s_mov_b32 s66, 0xfffff800
    s_mov_b32 s67, 0xffff8000
    v_cndmask_b32 v115, v146, 0, s[66:67]
    v_cndmask_b32 v131, v151, v146, s[66:67]
    s_mov_b32 s64, 0xffff0000
    s_mov_b32 s65, 0xfff00000
    v_cndmask_b32 v116, v146, 0, s[64:65]
    v_cndmask_b32 v132, v151, v146, s[64:65]
    s_mov_b32 s66, 0xfffe0000
    s_mov_b32 s67, 0xffe00000
    v_cndmask_b32 v117, v146, 0, s[66:67]
    v_cndmask_b32 v133, v151, v146, s[66:67]
    s_mov_b32 s64, 0xfffc0000
    s_mov_b32 s65, 0xffc00000
    v_cndmask_b32 v118, v146, 0, s[64:65]
    v_cndmask_b32 v134, v151, v146, s[64:65]
    s_mov_b32 s66, 0xfff80000
    s_mov_b32 s67, 0xff800000
    v_cndmask_b32 v119, v146, 0, s[66:67]
    v_cndmask_b32 v135, v151, v146, s[66:67]
    s_mov_b32 s64, 0xff000000
    s_mov_b32 s65, 0xf0000000
    v_cndmask_b32 v120, v146, 0, s[64:65]
    v_cndmask_b32 v136, v151, v146, s[64:65]
    s_mov_b32 s66, 0xfe000000
    s_mov_b32 s67, 0xe0000000
    v_cndmask_b32 v121, v146, 0, s[66:67]
    v_cndmask_b32 v137, v151, v146, s[66:67]
    s_mov_b32 s64, 0xfc000000
    s_mov_b32 s65, 0xc0000000
    v_cndmask_b32 v122, v146, 0, s[64:65]
    v_cndmask_b32 v138, v151, v146, s[64:65]
    s_mov_b32 s66, 0xf8000000
    s_mov_b32 s67, 0x80000000
    v_cndmask_b32 v123, v146, 0, s[66:67]
    v_cndmask_b32 v139, v151, v146, s[66:67]
    ds_write_b128 v148, v[108:111] offset:0
    ds_write_b128 v148, v[112:115] offset:1024
    ds_write_b128 v148, v[116:119] offset:2048
    ds_write_b128 v148, v[120:123] offset:3072
    ds_write_b128 v148, v[124:127] offset:11776
    ds_write_b128 v148, v[128:131] offset:12800
    ds_write_b128 v148, v[132:135] offset:13824
    ds_write_b128 v148, v[136:139] offset:14848
    s_waitcnt lgkmcnt(0)
    s_branch L_ld_wait
L_comp:
    s_waitcnt lgkmcnt(0)
    s_mov_b32 s20, s48
    s_mov_b32 s21, s49
    s_mov_b32 s22, 0x100
    s_mov_b32 s23, 0x00020000
    s_mov_b32 s16, s50
    s_mov_b32 s17, s51
    s_mov_b32 s18, 0x1800000
    s_mov_b32 s19, 0x00020000
    s_cmp_lg_u32 s52, 0
    s_cbranch_scc1 L_notw0
    s_mov_b32 s24, s44
    s_mov_b32 s25, s45
    s_mov_b32 s26, 0x400
    s_mov_b32 s27, 0x00020000
    s_lshl_b32 s59, s58, 7
    v_add_u32 v5, s59, v2
    v_and_b32 v5, 0x3ff, v5
    s_lshl_b32 s59, s31, 7
    v_xor_b32 v5, s59, v5
    s_mov_b32 m0, 153600
    v_mov_b32 v250, 163776
    buffer_load_dwordx4 v5, s[24:27], 0 offen lds
    v_mov_b32 v252, 0
    v_mov_b32 v253, 0
    v_mov_b32 v254, 0
    v_mov_b32 v255, 0
    ds_write_b128 v250, v[252:255] offset:0
    ds_write_b128 v250, v[252:255] offset:16
    ds_write_b128 v250, v[252:255] offset:32
    ds_write_b128 v250, v[252:255] offset:48
    s_cmp_lg_u32 s2, 0
    s_cbranch_scc1 L_notag
    s_memrealtime s[28:29]
    s_waitcnt lgkmcnt(0)
    s_or_b32 s29, s29, 0x40000000
    v_mov_b32 v254, s28
    v_mov_b32 v255, s29
    s_mov_b64 exec, 1
    buffer_store_dwordx2 v[254:255], v252, s[20:23], 0 offen sc1
    s_mov_b64 exec, -1
L_notag:
    s_waitcnt lgkmcnt(0)
L_notw0:
    s_lshl_b32 s33, s56, 2
    s_add_u32 s33, s33, s68
    s_lshl_b32 s59, s55, 8
    s_add_u32 s59, s59, s33
    s_lshl_b32 s70, s59, 11
    s_lshr_b32 s71, s70, 1
    s_cmp_eq_u32 s57, 0
    s_cbranch_scc1 L_noones
    v_lshrrev_b32 v5, 3, v1
    v_lshlrev_b32 v5, 9, v5
    v_and_b32 v6, 0x70, v2
    v_add_u32 v5, v5, v6
    v_mov_b32 v240, 0x3f803f80
    v_mov_b32 v241, 0x3f803f80
    v_mov_b32 v242, 0x3f803f80
    v_mov_b32 v243, 0x3f803f80
    s_lshl_b32 s59, s55, 6
    s_add_u32 s59, s59, s33
    s_lshl_b32 s59, s59, 11
    s_add_u32 s59, s59, 18874368
    s_mov_b64 exec, 0xffff
    buffer_store_dwordx4 v[240:243], v5, s[16:19], s59 offen offset:1024 sc1
    s_mov_b64 exec, -1
L_noones:
    v_and_b32 v10, 15, v1
    s_lshl_b32 s59, s68, 12
    v_lshlrev_b32 v11, 7, v10
    v_add_u32 v11, s59, v11
    v_bfe_u32 v12, v1, 1, 3
    v_lshrrev_b32 v13, 4, v1
    v_xor_b32 v12, v12, v13
    v_lshl_add_u32 v5, v12, 4, v11
    v_xor_b32 v6, 64, v5
    v_bfe_u32 v10, v1, 2, 2
    v_lshl_add_u32 v11, v13, 3, v10
    v_and_b32 v12, 3, v1
    v_lshlrev_b32 v12, 3, v12
    v_bfe_u32 v10, v1, 4, 1
    v_lshl_add_u32 v12, v10, 5, v12
    v_lshlrev_b32 v3, 17, v10
    v_lshl_add_u32 v244, v11, 6, v12
    v_xor_b32 v245, 32, v244
    v_lshl_add_u32 v4, v11, 7, v12
    v_bfe_u32 v10, v1, 3, 1
    v_lshl_add_u32 v4, v10, 6, v4
    v_xor_b32 v7, 32, v4
    v_xor_b32 v8, 64, v4
    v_xor_b32 v9, 96, v4
    v_lshrrev_b32 v10, 5, v1
    v_lshl_add_u32 v3, v10, 8, v3
    v_and_b32 v10, 15, v1
    v_lshl_add_u32 v3, v10, 4, v3
    s_mov_b32 s69, 0x3eb8aa3b
    v_lshlrev_b32 v0, 4, v13
    v_add_u32 v0, 153600, v0
    s_lshl_b32 s59, s68, 10
    s_add_u32 s59, s59, 131072
    v_add_u32 v248, s59, v2
    v_mov_b32 v10, 0
    v_mov_b32 v11, 0
    v_mov_b32 v14, 0
    v_mov_b32 v15, 0
    s_cmp_lg_u32 s57, 0
    s_cbranch_scc1 L_p1_v
    s_barrier
    ds_read_b128 v[16:19], v5 offset:0
    ds_read_b128 v[20:23], v5 offset:2048
    ds_read_b64_tr_b16 v[144:145], v4 offset:16384
    ds_read_b64_tr_b16 v[146:147], v4 offset:16896
    ds_read_b64_tr_b16 v[148:149], v7 offset:16384
    ds_read_b64_tr_b16 v[150:151], v7 offset:16896
    ds_read_b64_tr_b16 v[152:153], v8 offset:16384
    ds_read_b64_tr_b16 v[154:155], v8 offset:16896
    ds_read_b64_tr_b16 v[156:157], v9 offset:16384
    ds_read_b64_tr_b16 v[158:159], v9 offset:16896
    ds_read_b64_tr_b16 v[224:225], v244 offset:24576
    ds_read_b64_tr_b16 v[226:227], v244 offset:24832
    ds_read_b64_tr_b16 v[228:229], v245 offset:24576
    ds_read_b64_tr_b16 v[230:231], v245 offset:24832
    s_waitcnt lgkmcnt(10)
    v_mfma_f32_16x16x32_bf16 v[176:179], v[144:147], v[16:19], 0
    ds_read_b128 v[24:27], v6 offset:0
    ds_read_b128 v[28:31], v6 offset:2048
    v_mfma_f32_16x16x32_bf16 v[180:183], v[144:147], v[20:23], 0
    ds_read_b64_tr_b16 v[160:161], v4 offset:20480
    ds_read_b64_tr_b16 v[162:163], v4 offset:20992
    s_waitcnt lgkmcnt(12)
    v_mfma_f32_16x16x32_bf16 v[184:187], v[148:151], v[16:19], 0
    ds_read_b64_tr_b16 v[164:165], v7 offset:20480
    v_mfma_f32_16x16x32_bf16 v[188:191], v[148:151], v[20:23], 0
    ds_read_b64_tr_b16 v[166:167], v7 offset:20992
    s_waitcnt lgkmcnt(12)
    v_mfma_f32_16x16x32_bf16 v[192:195], v[152:155], v[16:19], 0
    ds_read_b64_tr_b16 v[168:169], v8 offset:20480
    v_mfma_f32_16x16x32_bf16 v[196:199], v[152:155], v[20:23], 0
    ds_read_b64_tr_b16 v[170:171], v8 offset:20992
    s_waitcnt lgkmcnt(12)
    v_mfma_f32_16x16x32_bf16 v[200:203], v[156:159], v[16:19], 0
    ds_read_b64_tr_b16 v[172:173], v9 offset:20480
    v_mfma_f32_16x16x32_bf16 v[204:207], v[156:159], v[20:23], 0
    ds_read_b64_tr_b16 v[174:175], v9 offset:20992
    s_waitcnt lgkmcnt(12)
    v_mfma_f32_16x16x32_bf16 v[208:211], v[224:227], v[16:19], 0
    ds_read_b64_tr_b16 v[232:233], v244 offset:26624
    v_mfma_f32_16x16x32_bf16 v[212:215], v[224:227], v[20:23], 0
    ds_read_b64_tr_b16 v[234:235], v244 offset:26880
    s_waitcnt lgkmcnt(12)
    v_mfma_f32_16x16x32_bf16 v[216:219], v[228:231], v[16:19], 0
    ds_read_b64_tr_b16 v[236:237], v245 offset:26624
    v_mfma_f32_16x16x32_bf16 v[220:223], v[228:231], v[20:23], 0
    ds_read_b64_tr_b16 v[238:239], v245 offset:26880
    s_waitcnt lgkmcnt(10)
    v_mfma_f32_16x16x32_bf16 v[176:179], v[160:163], v[24:27], v[176:179]
    s_barrier
    ds_read_b128 v[32:35], v5 offset:32768
    ds_read_b128 v[36:39], v5 offset:34816
    v_mfma_f32_16x16x32_bf16 v[180:183], v[160:163], v[28:31], v[180:183]
    ds_read_b64_tr_b16 v[144:145], v4 offset:49152
    ds_read_b64_tr_b16 v[146:147], v4 offset:49664
    s_waitcnt lgkmcnt(12)
    v_mfma_f32_16x16x32_bf16 v[184:187], v[164:167], v[24:27], v[184:187]
    ds_read_b64_tr_b16 v[148:149], v7 offset:49152
    v_mfma_f32_16x16x32_bf16 v[188:191], v[164:167], v[28:31], v[188:191]
    ds_read_b64_tr_b16 v[150:151], v7 offset:49664
    s_waitcnt lgkmcnt(12)
    v_mfma_f32_16x16x32_bf16 v[192:195], v[168:171], v[24:27], v[192:195]
    ds_read_b64_tr_b16 v[152:153], v8 offset:49152
    v_mfma_f32_16x16x32_bf16 v[196:199], v[168:171], v[28:31], v[196:199]
    ds_read_b64_tr_b16 v[154:155], v8 offset:49664
    s_waitcnt lgkmcnt(12)
    v_mfma_f32_16x16x32_bf16 v[200:203], v[172:175], v[24:27], v[200:203]
    ds_read_b64_tr_b16 v[156:157], v9 offset:49152
    v_mfma_f32_16x16x32_bf16 v[204:207], v[172:175], v[28:31], v[204:207]
    ds_read_b64_tr_b16 v[158:159], v9 offset:49664
    s_waitcnt lgkmcnt(12)
    v_mfma_f32_16x16x32_bf16 v[208:211], v[232:235], v[24:27], v[208:211]
    ds_read_b64_tr_b16 v[224:225], v244 offset:57344
    v_mfma_f32_16x16x32_bf16 v[212:215], v[232:235], v[28:31], v[212:215]
    ds_read_b64_tr_b16 v[226:227], v244 offset:57600
    s_waitcnt lgkmcnt(12)
    v_mfma_f32_16x16x32_bf16 v[216:219], v[236:239], v[24:27], v[216:219]
    ds_read_b64_tr_b16 v[228:229], v245 offset:57344
    v_mfma_f32_16x16x32_bf16 v[220:223], v[236:239], v[28:31], v[220:223]
    ds_read_b64_tr_b16 v[230:231], v245 offset:57600
    s_waitcnt lgkmcnt(10)
    v_mfma_f32_16x16x32_bf16 v[176:179], v[144:147], v[32:35], v[176:179]
    ds_read_b128 v[40:43], v6 offset:32768
    ds_read_b128 v[44:47], v6 offset:34816
    v_mfma_f32_16x16x32_bf16 v[180:183], v[144:147], v[36:39], v[180:183]
    ds_read_b64_tr_b16 v[160:161], v4 offset:53248
    ds_read_b64_tr_b16 v[162:163], v4 offset:53760
    s_waitcnt lgkmcnt(12)
    v_mfma_f32_16x16x32_bf16 v[184:187], v[148:151], v[32:35], v[184:187]
    ds_read_b64_tr_b16 v[164:165], v7 offset:53248
    v_mfma_f32_16x16x32_bf16 v[188:191], v[148:151], v[36:39], v[188:191]
    ds_read_b64_tr_b16 v[166:167], v7 offset:53760
    s_waitcnt lgkmcnt(12)
    v_mfma_f32_16x16x32_bf16 v[192:195], v[152:155], v[32:35], v[192:195]
    ds_read_b64_tr_b16 v[168:169], v8 offset:53248
    v_mfma_f32_16x16x32_bf16 v[196:199], v[152:155], v[36:39], v[196:199]
    ds_read_b64_tr_b16 v[170:171], v8 offset:53760
    s_waitcnt lgkmcnt(12)
    v_mfma_f32_16x16x32_bf16 v[200:203], v[156:159], v[32:35], v[200:203]
    ds_read_b64_tr_b16 v[172:173], v9 offset:53248
    v_mfma_f32_16x16x32_bf16 v[204:207], v[156:159], v[36:39], v[204:207]
    ds_read_b64_tr_b16 v[174:175], v9 offset:53760
    s_waitcnt lgkmcnt(12)
    v_mfma_f32_16x16x32_bf16 v[208:211], v[224:227], v[32:35], v[208:211]
    ds_read_b64_tr_b16 v[232:233], v244 offset:59392
    v_mfma_f32_16x16x32_bf16 v[212:215], v[224:227], v[36:39], v[212:215]
    ds_read_b64_tr_b16 v[234:235], v244 offset:59648
    s_waitcnt lgkmcnt(12)
    v_mfma_f32_16x16x32_bf16 v[216:219], v[228:231], v[32:35], v[216:219]
    ds_read_b64_tr_b16 v[236:237], v245 offset:59392
    v_mfma_f32_16x16x32_bf16 v[220:223], v[228:231], v[36:39], v[220:223]
    ds_read_b64_tr_b16 v[238:239], v245 offset:59648
    s_waitcnt lgkmcnt(10)
    v_mfma_f32_16x16x32_bf16 v[176:179], v[160:163], v[40:43], v[176:179]
    s_barrier
    v_xor_b32 v5, 0x10000, v5
    v_xor_b32 v6, 0x10000, v6
    v_xor_b32 v4, 0x10000, v4
    v_xor_b32 v7, 0x10000, v7
    v_xor_b32 v8, 0x10000, v8
    v_xor_b32 v9, 0x10000, v9
    v_xor_b32 v244, 0x10000, v244
    v_xor_b32 v245, 0x10000, v245
    ds_read_b128 v[48:51], v5 offset:0
    ds_read_b128 v[52:55], v5 offset:2048
    v_mfma_f32_16x16x32_bf16 v[180:183], v[160:163], v[44:47], v[180:183]
    ds_read_b64_tr_b16 v[144:145], v4 offset:16384
    ds_read_b64_tr_b16 v[146:147], v4 offset:16896
    s_waitcnt lgkmcnt(12)
    v_mfma_f32_16x16x32_bf16 v[184:187], v[164:167], v[40:43], v[184:187]
    ds_read_b64_tr_b16 v[148:149], v7 offset:16384
    v_mfma_f32_16x16x32_bf16 v[188:191], v[164:167], v[44:47], v[188:191]
    ds_read_b64_tr_b16 v[150:151], v7 offset:16896
    s_waitcnt lgkmcnt(12)
    v_mfma_f32_16x16x32_bf16 v[192:195], v[168:171], v[40:43], v[192:195]
    ds_read_b64_tr_b16 v[152:153], v8 offset:16384
    v_mfma_f32_16x16x32_bf16 v[196:199], v[168:171], v[44:47], v[196:199]
    ds_read_b64_tr_b16 v[154:155], v8 offset:16896
    s_waitcnt lgkmcnt(12)
    v_mfma_f32_16x16x32_bf16 v[200:203], v[172:175], v[40:43], v[200:203]
    ds_read_b64_tr_b16 v[156:157], v9 offset:16384
    v_mfma_f32_16x16x32_bf16 v[204:207], v[172:175], v[44:47], v[204:207]
    ds_read_b64_tr_b16 v[158:159], v9 offset:16896
    s_waitcnt lgkmcnt(12)
    v_mfma_f32_16x16x32_bf16 v[208:211], v[232:235], v[40:43], v[208:211]
    ds_read_b64_tr_b16 v[224:225], v244 offset:24576
    v_mfma_f32_16x16x32_bf16 v[212:215], v[232:235], v[44:47], v[212:215]
    ds_read_b64_tr_b16 v[226:227], v244 offset:24832
    s_waitcnt lgkmcnt(12)
    v_mfma_f32_16x16x32_bf16 v[216:219], v[236:239], v[40:43], v[216:219]
    ds_read_b64_tr_b16 v[228:229], v245 offset:24576
    v_mfma_f32_16x16x32_bf16 v[220:223], v[236:239], v[44:47], v[220:223]
    ds_read_b64_tr_b16 v[230:231], v245 offset:24832
    s_waitcnt lgkmcnt(10)
    v_mfma_f32_16x16x32_bf16 v[176:179], v[144:147], v[48:51], v[176:179]
    ds_read_b128 v[56:59], v6 offset:0
    ds_read_b128 v[60:63], v6 offset:2048
    v_mfma_f32_16x16x32_bf16 v[180:183], v[144:147], v[52:55], v[180:183]
    ds_read_b64_tr_b16 v[160:161], v4 offset:20480
    ds_read_b64_tr_b16 v[162:163], v4 offset:20992
    s_waitcnt lgkmcnt(12)
    v_mfma_f32_16x16x32_bf16 v[184:187], v[148:151], v[48:51], v[184:187]
    ds_read_b64_tr_b16 v[164:165], v7 offset:20480
    v_mfma_f32_16x16x32_bf16 v[188:191], v[148:151], v[52:55], v[188:191]
    ds_read_b64_tr_b16 v[166:167], v7 offset:20992
    s_waitcnt lgkmcnt(12)
    v_mfma_f32_16x16x32_bf16 v[192:195], v[152:155], v[48:51], v[192:195]
    ds_read_b64_tr_b16 v[168:169], v8 offset:20480
    v_mfma_f32_16x16x32_bf16 v[196:199], v[152:155], v[52:55], v[196:199]
    ds_read_b64_tr_b16 v[170:171], v8 offset:20992
    s_waitcnt lgkmcnt(12)
    v_mfma_f32_16x16x32_bf16 v[200:203], v[156:159], v[48:51], v[200:203]
    ds_read_b64_tr_b16 v[172:173], v9 offset:20480
    v_mfma_f32_16x16x32_bf16 v[204:207], v[156:159], v[52:55], v[204:207]
    ds_read_b64_tr_b16 v[174:175], v9 offset:20992
    s_waitcnt lgkmcnt(12)
    v_mfma_f32_16x16x32_bf16 v[208:211], v[224:227], v[48:51], v[208:211]
    ds_read_b64_tr_b16 v[232:233], v244 offset:26624
    v_mfma_f32_16x16x32_bf16 v[212:215], v[224:227], v[52:55], v[212:215]
    ds_read_b64_tr_b16 v[234:235], v244 offset:26880
    s_waitcnt lgkmcnt(12)
    v_mfma_f32_16x16x32_bf16 v[216:219], v[228:231], v[48:51], v[216:219]
    ds_read_b64_tr_b16 v[236:237], v245 offset:26624
    v_mfma_f32_16x16x32_bf16 v[220:223], v[228:231], v[52:55], v[220:223]
    ds_read_b64_tr_b16 v[238:239], v245 offset:26880
    s_waitcnt lgkmcnt(10)
    v_mfma_f32_16x16x32_bf16 v[176:179], v[160:163], v[56:59], v[176:179]
    s_barrier
    ds_read_b128 v[64:67], v5 offset:32768
    ds_read_b128 v[68:71], v5 offset:34816
    v_mfma_f32_16x16x32_bf16 v[180:183], v[160:163], v[60:63], v[180:183]
    ds_read_b64_tr_b16 v[144:145], v4 offset:49152
    ds_read_b64_tr_b16 v[146:147], v4 offset:49664
    s_waitcnt lgkmcnt(12)
    v_mfma_f32_16x16x32_bf16 v[184:187], v[164:167], v[56:59], v[184:187]
    ds_read_b64_tr_b16 v[148:149], v7 offset:49152
    v_mfma_f32_16x16x32_bf16 v[188:191], v[164:167], v[60:63], v[188:191]
    ds_read_b64_tr_b16 v[150:151], v7 offset:49664
    s_waitcnt lgkmcnt(12)
    v_mfma_f32_16x16x32_bf16 v[192:195], v[168:171], v[56:59], v[192:195]
    ds_read_b64_tr_b16 v[152:153], v8 offset:49152
    v_mfma_f32_16x16x32_bf16 v[196:199], v[168:171], v[60:63], v[196:199]
    ds_read_b64_tr_b16 v[154:155], v8 offset:49664
    s_waitcnt lgkmcnt(12)
    v_mfma_f32_16x16x32_bf16 v[200:203], v[172:175], v[56:59], v[200:203]
    ds_read_b64_tr_b16 v[156:157], v9 offset:49152
    v_mfma_f32_16x16x32_bf16 v[204:207], v[172:175], v[60:63], v[204:207]
    ds_read_b64_tr_b16 v[158:159], v9 offset:49664
    s_waitcnt lgkmcnt(12)
    v_mfma_f32_16x16x32_bf16 v[208:211], v[232:235], v[56:59], v[208:211]
    ds_read_b64_tr_b16 v[224:225], v244 offset:57344
    v_mfma_f32_16x16x32_bf16 v[212:215], v[232:235], v[60:63], v[212:215]
    ds_read_b64_tr_b16 v[226:227], v244 offset:57600
    s_waitcnt lgkmcnt(12)
    v_mfma_f32_16x16x32_bf16 v[216:219], v[236:239], v[56:59], v[216:219]
    ds_read_b64_tr_b16 v[228:229], v245 offset:57344
    v_mfma_f32_16x16x32_bf16 v[220:223], v[236:239], v[60:63], v[220:223]
    ds_read_b64_tr_b16 v[230:231], v245 offset:57600
    s_waitcnt lgkmcnt(10)
    v_mfma_f32_16x16x32_bf16 v[176:179], v[144:147], v[64:67], v[176:179]
    ds_read_b128 v[72:75], v6 offset:32768
    ds_read_b128 v[76:79], v6 offset:34816
    v_mfma_f32_16x16x32_bf16 v[180:183], v[144:147], v[68:71], v[180:183]
    ds_read_b64_tr_b16 v[160:161], v4 offset:53248
    ds_read_b64_tr_b16 v[162:163], v4 offset:53760
    s_waitcnt lgkmcnt(12)
    v_mfma_f32_16x16x32_bf16 v[184:187], v[148:151], v[64:67], v[184:187]
    ds_read_b64_tr_b16 v[164:165], v7 offset:53248
    v_mfma_f32_16x16x32_bf16 v[188:191], v[148:151], v[68:71], v[188:191]
    ds_read_b64_tr_b16 v[166:167], v7 offset:53760
    s_waitcnt lgkmcnt(12)
    v_mfma_f32_16x16x32_bf16 v[192:195], v[152:155], v[64:67], v[192:195]
    ds_read_b64_tr_b16 v[168:169], v8 offset:53248
    v_mfma_f32_16x16x32_bf16 v[196:199], v[152:155], v[68:71], v[196:199]
    ds_read_b64_tr_b16 v[170:171], v8 offset:53760
    s_waitcnt lgkmcnt(12)
    v_mfma_f32_16x16x32_bf16 v[200:203], v[156:159], v[64:67], v[200:203]
    ds_read_b64_tr_b16 v[172:173], v9 offset:53248
    v_mfma_f32_16x16x32_bf16 v[204:207], v[156:159], v[68:71], v[204:207]
    ds_read_b64_tr_b16 v[174:175], v9 offset:53760
    s_waitcnt lgkmcnt(12)
    v_mfma_f32_16x16x32_bf16 v[208:211], v[224:227], v[64:67], v[208:211]
    ds_read_b64_tr_b16 v[232:233], v244 offset:59392
    v_mfma_f32_16x16x32_bf16 v[212:215], v[224:227], v[68:71], v[212:215]
    ds_read_b64_tr_b16 v[234:235], v244 offset:59648
    s_waitcnt lgkmcnt(12)
    v_mfma_f32_16x16x32_bf16 v[216:219], v[228:231], v[64:67], v[216:219]
    ds_read_b64_tr_b16 v[236:237], v245 offset:59392
    v_mfma_f32_16x16x32_bf16 v[220:223], v[228:231], v[68:71], v[220:223]
    ds_read_b64_tr_b16 v[238:239], v245 offset:59648
    s_waitcnt lgkmcnt(10)
    v_mfma_f32_16x16x32_bf16 v[176:179], v[160:163], v[72:75], v[176:179]
    s_barrier
    v_xor_b32 v5, 0x10000, v5
    v_xor_b32 v6, 0x10000, v6
    v_xor_b32 v4, 0x10000, v4
    v_xor_b32 v7, 0x10000, v7
    v_xor_b32 v8, 0x10000, v8
    v_xor_b32 v9, 0x10000, v9
    v_xor_b32 v244, 0x10000, v244
    v_xor_b32 v245, 0x10000, v245
    ds_read_b128 v[80:83], v5 offset:0
    ds_read_b128 v[84:87], v5 offset:2048
    v_mfma_f32_16x16x32_bf16 v[180:183], v[160:163], v[76:79], v[180:183]
    ds_read_b64_tr_b16 v[144:145], v4 offset:16384
    ds_read_b64_tr_b16 v[146:147], v4 offset:16896
    s_waitcnt lgkmcnt(12)
    v_mfma_f32_16x16x32_bf16 v[184:187], v[164:167], v[72:75], v[184:187]
    ds_read_b64_tr_b16 v[148:149], v7 offset:16384
    v_mfma_f32_16x16x32_bf16 v[188:191], v[164:167], v[76:79], v[188:191]
    ds_read_b64_tr_b16 v[150:151], v7 offset:16896
    s_waitcnt lgkmcnt(12)
    v_mfma_f32_16x16x32_bf16 v[192:195], v[168:171], v[72:75], v[192:195]
    ds_read_b64_tr_b16 v[152:153], v8 offset:16384
    v_mfma_f32_16x16x32_bf16 v[196:199], v[168:171], v[76:79], v[196:199]
    ds_read_b64_tr_b16 v[154:155], v8 offset:16896
    s_waitcnt lgkmcnt(12)
    v_mfma_f32_16x16x32_bf16 v[200:203], v[172:175], v[72:75], v[200:203]
    ds_read_b64_tr_b16 v[156:157], v9 offset:16384
    v_mfma_f32_16x16x32_bf16 v[204:207], v[172:175], v[76:79], v[204:207]
    ds_read_b64_tr_b16 v[158:159], v9 offset:16896
    s_waitcnt lgkmcnt(12)
    v_mfma_f32_16x16x32_bf16 v[208:211], v[232:235], v[72:75], v[208:211]
    ds_read_b64_tr_b16 v[224:225], v244 offset:24576
    v_mfma_f32_16x16x32_bf16 v[212:215], v[232:235], v[76:79], v[212:215]
    ds_read_b64_tr_b16 v[226:227], v244 offset:24832
    s_waitcnt lgkmcnt(12)
    v_mfma_f32_16x16x32_bf16 v[216:219], v[236:239], v[72:75], v[216:219]
    ds_read_b64_tr_b16 v[228:229], v245 offset:24576
    v_mfma_f32_16x16x32_bf16 v[220:223], v[236:239], v[76:79], v[220:223]
    ds_read_b64_tr_b16 v[230:231], v245 offset:24832
    s_waitcnt vmcnt(0)
    v_mov_b32 v249, 0
    buffer_load_dwordx2 v[254:255], v249, s[20:23], 0 offen sc1
    s_waitcnt lgkmcnt(10)
    v_mfma_f32_16x16x32_bf16 v[176:179], v[144:147], v[80:83], v[176:179]
    ds_read_b128 v[88:91], v6 offset:0
    ds_read_b128 v[92:95], v6 offset:2048
    v_mfma_f32_16x16x32_bf16 v[180:183], v[144:147], v[84:87], v[180:183]
    ds_read_b64_tr_b16 v[160:161], v4 offset:20480
    ds_read_b64_tr_b16 v[162:163], v4 offset:20992
    s_waitcnt lgkmcnt(12)
    v_mfma_f32_16x16x32_bf16 v[184:187], v[148:151], v[80:83], v[184:187]
    ds_read_b64_tr_b16 v[164:165], v7 offset:20480
    v_mfma_f32_16x16x32_bf16 v[188:191], v[148:151], v[84:87], v[188:191]
    ds_read_b64_tr_b16 v[166:167], v7 offset:20992
    s_waitcnt lgkmcnt(12)
    v_mfma_f32_16x16x32_bf16 v[192:195], v[152:155], v[80:83], v[192:195]
    ds_read_b64_tr_b16 v[168:169], v8 offset:20480
    v_mfma_f32_16x16x32_bf16 v[196:199], v[152:155], v[84:87], v[196:199]
    ds_read_b64_tr_b16 v[170:171], v8 offset:20992
    s_waitcnt lgkmcnt(12)
    v_mfma_f32_16x16x32_bf16 v[200:203], v[156:159], v[80:83], v[200:203]
    ds_read_b64_tr_b16 v[172:173], v9 offset:20480
    v_mfma_f32_16x16x32_bf16 v[204:207], v[156:159], v[84:87], v[204:207]
    ds_read_b64_tr_b16 v[174:175], v9 offset:20992
    s_waitcnt lgkmcnt(12)
    v_mfma_f32_16x16x32_bf16 v[208:211], v[224:227], v[80:83], v[208:211]
    ds_read_b64_tr_b16 v[232:233], v244 offset:26624
    v_mfma_f32_16x16x32_bf16 v[212:215], v[224:227], v[84:87], v[212:215]
    ds_read_b64_tr_b16 v[234:235], v244 offset:26880
    s_waitcnt lgkmcnt(12)
    v_mfma_f32_16x16x32_bf16 v[216:219], v[228:231], v[80:83], v[216:219]
    ds_read_b64_tr_b16 v[236:237], v245 offset:26624
    v_mfma_f32_16x16x32_bf16 v[220:223], v[228:231], v[84:87], v[220:223]
    ds_read_b64_tr_b16 v[238:239], v245 offset:26880
    s_waitcnt lgkmcnt(10)
    v_mfma_f32_16x16x32_bf16 v[176:179], v[160:163], v[88:91], v[176:179]
    s_barrier
    ds_read_b128 v[96:99], v5 offset:32768
    ds_read_b128 v[100:103], v5 offset:34816
    v_mfma_f32_16x16x32_bf16 v[180:183], v[160:163], v[92:95], v[180:183]
    ds_read_b64_tr_b16 v[144:145], v4 offset:49152
    ds_read_b64_tr_b16 v[146:147], v4 offset:49664
    s_waitcnt lgkmcnt(12)
    v_mfma_f32_16x16x32_bf16 v[184:187], v[164:167], v[88:91], v[184:187]
    ds_read_b64_tr_b16 v[148:149], v7 offset:49152
    v_mfma_f32_16x16x32_bf16 v[188:191], v[164:167], v[92:95], v[188:191]
    ds_read_b64_tr_b16 v[150:151], v7 offset:49664
    s_waitcnt lgkmcnt(12)
    v_mfma_f32_16x16x32_bf16 v[192:195], v[168:171], v[88:91], v[192:195]
    ds_read_b64_tr_b16 v[152:153], v8 offset:49152
    v_mfma_f32_16x16x32_bf16 v[196:199], v[168:171], v[92:95], v[196:199]
    ds_read_b64_tr_b16 v[154:155], v8 offset:49664
    s_waitcnt lgkmcnt(12)
    v_mfma_f32_16x16x32_bf16 v[200:203], v[172:175], v[88:91], v[200:203]
    ds_read_b64_tr_b16 v[156:157], v9 offset:49152
    v_mfma_f32_16x16x32_bf16 v[204:207], v[172:175], v[92:95], v[204:207]
    ds_read_b64_tr_b16 v[158:159], v9 offset:49664
    s_waitcnt lgkmcnt(12)
    v_mfma_f32_16x16x32_bf16 v[208:211], v[232:235], v[88:91], v[208:211]
    ds_read_b64_tr_b16 v[224:225], v244 offset:57344
    v_mfma_f32_16x16x32_bf16 v[212:215], v[232:235], v[92:95], v[212:215]
    ds_read_b64_tr_b16 v[226:227], v244 offset:57600
    s_waitcnt lgkmcnt(12)
    v_mfma_f32_16x16x32_bf16 v[216:219], v[236:239], v[88:91], v[216:219]
    ds_read_b64_tr_b16 v[228:229], v245 offset:57344
    v_mfma_f32_16x16x32_bf16 v[220:223], v[236:239], v[92:95], v[220:223]
    ds_read_b64_tr_b16 v[230:231], v245 offset:57600
    s_waitcnt lgkmcnt(10)
    v_mfma_f32_16x16x32_bf16 v[176:179], v[144:147], v[96:99], v[176:179]
    ds_read_b128 v[104:107], v6 offset:32768
    ds_read_b128 v[108:111], v6 offset:34816
    v_mfma_f32_16x16x32_bf16 v[180:183], v[144:147], v[100:103], v[180:183]
    ds_read_b64_tr_b16 v[160:161], v4 offset:53248
    ds_read_b64_tr_b16 v[162:163], v4 offset:53760
    s_waitcnt lgkmcnt(12)
    v_mfma_f32_16x16x32_bf16 v[184:187], v[148:151], v[96:99], v[184:187]
    ds_read_b64_tr_b16 v[164:165], v7 offset:53248
    v_mfma_f32_16x16x32_bf16 v[188:191], v[148:151], v[100:103], v[188:191]
    ds_read_b64_tr_b16 v[166:167], v7 offset:53760
    s_waitcnt lgkmcnt(12)
    v_mfma_f32_16x16x32_bf16 v[192:195], v[152:155], v[96:99], v[192:195]
    ds_read_b64_tr_b16 v[168:169], v8 offset:53248
    v_mfma_f32_16x16x32_bf16 v[196:199], v[152:155], v[100:103], v[196:199]
    ds_read_b64_tr_b16 v[170:171], v8 offset:53760
    s_waitcnt lgkmcnt(12)
    v_mfma_f32_16x16x32_bf16 v[200:203], v[156:159], v[96:99], v[200:203]
    ds_read_b64_tr_b16 v[172:173], v9 offset:53248
    v_mfma_f32_16x16x32_bf16 v[204:207], v[156:159], v[100:103], v[204:207]
    ds_read_b64_tr_b16 v[174:175], v9 offset:53760
    s_waitcnt lgkmcnt(12)
    v_mfma_f32_16x16x32_bf16 v[208:211], v[224:227], v[96:99], v[208:211]
    ds_read_b64_tr_b16 v[232:233], v244 offset:59392
    v_mfma_f32_16x16x32_bf16 v[212:215], v[224:227], v[100:103], v[212:215]
    ds_read_b64_tr_b16 v[234:235], v244 offset:59648
    s_waitcnt lgkmcnt(12)
    v_mfma_f32_16x16x32_bf16 v[216:219], v[228:231], v[96:99], v[216:219]
    ds_read_b64_tr_b16 v[236:237], v245 offset:59392
    v_mfma_f32_16x16x32_bf16 v[220:223], v[228:231], v[100:103], v[220:223]
    ds_read_b64_tr_b16 v[238:239], v245 offset:59648
    s_waitcnt lgkmcnt(10)
    v_mfma_f32_16x16x32_bf16 v[176:179], v[160:163], v[104:107], v[176:179]
    s_barrier
    v_xor_b32 v5, 0x10000, v5
    v_xor_b32 v6, 0x10000, v6
    v_xor_b32 v4, 0x10000, v4
    v_xor_b32 v7, 0x10000, v7
    v_xor_b32 v8, 0x10000, v8
    v_xor_b32 v9, 0x10000, v9
    v_xor_b32 v244, 0x10000, v244
    v_xor_b32 v245, 0x10000, v245
    ds_read_b128 v[112:115], v5 offset:0
    ds_read_b128 v[116:119], v5 offset:2048
    v_mfma_f32_16x16x32_bf16 v[180:183], v[160:163], v[108:111], v[180:183]
    ds_read_b64_tr_b16 v[144:145], v4 offset:16384
    ds_read_b64_tr_b16 v[146:147], v4 offset:16896
    s_waitcnt lgkmcnt(12)
    v_mfma_f32_16x16x32_bf16 v[184:187], v[164:167], v[104:107], v[184:187]
    ds_read_b64_tr_b16 v[148:149], v7 offset:16384
    v_mfma_f32_16x16x32_bf16 v[188:191], v[164:167], v[108:111], v[188:191]
    ds_read_b64_tr_b16 v[150:151], v7 offset:16896
    s_waitcnt lgkmcnt(12)
    v_mfma_f32_16x16x32_bf16 v[192:195], v[168:171], v[104:107], v[192:195]
    ds_read_b64_tr_b16 v[152:153], v8 offset:16384
    v_mfma_f32_16x16x32_bf16 v[196:199], v[168:171], v[108:111], v[196:199]
    ds_read_b64_tr_b16 v[154:155], v8 offset:16896
    s_waitcnt lgkmcnt(12)
    v_mfma_f32_16x16x32_bf16 v[200:203], v[172:175], v[104:107], v[200:203]
    ds_read_b64_tr_b16 v[156:157], v9 offset:16384
    v_mfma_f32_16x16x32_bf16 v[204:207], v[172:175], v[108:111], v[204:207]
    ds_read_b64_tr_b16 v[158:159], v9 offset:16896
    s_waitcnt lgkmcnt(12)
    v_mfma_f32_16x16x32_bf16 v[208:211], v[232:235], v[104:107], v[208:211]
    ds_read_b64_tr_b16 v[224:225], v244 offset:24576
    v_mfma_f32_16x16x32_bf16 v[212:215], v[232:235], v[108:111], v[212:215]
    ds_read_b64_tr_b16 v[226:227], v244 offset:24832
    s_waitcnt lgkmcnt(12)
    v_mfma_f32_16x16x32_bf16 v[216:219], v[236:239], v[104:107], v[216:219]
    ds_read_b64_tr_b16 v[228:229], v245 offset:24576
    v_mfma_f32_16x16x32_bf16 v[220:223], v[236:239], v[108:111], v[220:223]
    ds_read_b64_tr_b16 v[230:231], v245 offset:24832
    s_waitcnt lgkmcnt(10)
    v_mfma_f32_16x16x32_bf16 v[176:179], v[144:147], v[112:115], v[176:179]
    ds_read_b128 v[120:123], v6 offset:0
    ds_read_b128 v[124:127], v6 offset:2048
    v_mfma_f32_16x16x32_bf16 v[180:183], v[144:147], v[116:119], v[180:183]
    ds_read_b64_tr_b16 v[160:161], v4 offset:20480
    ds_read_b64_tr_b16 v[162:163], v4 offset:20992
    s_waitcnt lgkmcnt(12)
    v_mfma_f32_16x16x32_bf16 v[184:187], v[148:151], v[112:115], v[184:187]
    ds_read_b64_tr_b16 v[164:165], v7 offset:20480
    v_mfma_f32_16x16x32_bf16 v[188:191], v[148:151], v[116:119], v[188:191]
    ds_read_b64_tr_b16 v[166:167], v7 offset:20992
    s_waitcnt lgkmcnt(12)
    v_mfma_f32_16x16x32_bf16 v[192:195], v[152:155], v[112:115], v[192:195]
    ds_read_b64_tr_b16 v[168:169], v8 offset:20480
    v_mfma_f32_16x16x32_bf16 v[196:199], v[152:155], v[116:119], v[196:199]
    ds_read_b64_tr_b16 v[170:171], v8 offset:20992
    s_waitcnt lgkmcnt(12)
    v_mfma_f32_16x16x32_bf16 v[200:203], v[156:159], v[112:115], v[200:203]
    ds_read_b64_tr_b16 v[172:173], v9 offset:20480
    v_mfma_f32_16x16x32_bf16 v[204:207], v[156:159], v[116:119], v[204:207]
    ds_read_b64_tr_b16 v[174:175], v9 offset:20992
    s_waitcnt lgkmcnt(12)
    v_mfma_f32_16x16x32_bf16 v[208:211], v[224:227], v[112:115], v[208:211]
    ds_read_b64_tr_b16 v[232:233], v244 offset:26624
    v_mfma_f32_16x16x32_bf16 v[212:215], v[224:227], v[116:119], v[212:215]
    ds_read_b64_tr_b16 v[234:235], v244 offset:26880
    s_waitcnt lgkmcnt(12)
    v_mfma_f32_16x16x32_bf16 v[216:219], v[228:231], v[112:115], v[216:219]
    ds_read_b64_tr_b16 v[236:237], v245 offset:26624
    v_mfma_f32_16x16x32_bf16 v[220:223], v[228:231], v[116:119], v[220:223]
    ds_read_b64_tr_b16 v[238:239], v245 offset:26880
    s_waitcnt lgkmcnt(10)
    v_mfma_f32_16x16x32_bf16 v[176:179], v[160:163], v[120:123], v[176:179]
    s_barrier
    ds_read_b128 v[128:131], v5 offset:32768
    ds_read_b128 v[132:135], v5 offset:34816
    v_mfma_f32_16x16x32_bf16 v[180:183], v[160:163], v[124:127], v[180:183]
    ds_read_b64_tr_b16 v[144:145], v4 offset:49152
    ds_read_b64_tr_b16 v[146:147], v4 offset:49664
    s_waitcnt lgkmcnt(12)
    v_mfma_f32_16x16x32_bf16 v[184:187], v[164:167], v[120:123], v[184:187]
    ds_read_b64_tr_b16 v[148:149], v7 offset:49152
    v_mfma_f32_16x16x32_bf16 v[188:191], v[164:167], v[124:127], v[188:191]
    ds_read_b64_tr_b16 v[150:151], v7 offset:49664
    s_waitcnt lgkmcnt(12)
    v_mfma_f32_16x16x32_bf16 v[192:195], v[168:171], v[120:123], v[192:195]
    ds_read_b64_tr_b16 v[152:153], v8 offset:49152
    v_mfma_f32_16x16x32_bf16 v[196:199], v[168:171], v[124:127], v[196:199]
    ds_read_b64_tr_b16 v[154:155], v8 offset:49664
    s_waitcnt lgkmcnt(12)
    v_mfma_f32_16x16x32_bf16 v[200:203], v[172:175], v[120:123], v[200:203]
    ds_read_b64_tr_b16 v[156:157], v9 offset:49152
    v_mfma_f32_16x16x32_bf16 v[204:207], v[172:175], v[124:127], v[204:207]
    ds_read_b64_tr_b16 v[158:159], v9 offset:49664
    s_waitcnt lgkmcnt(12)
    v_mfma_f32_16x16x32_bf16 v[208:211], v[232:235], v[120:123], v[208:211]
    ds_read_b64_tr_b16 v[224:225], v244 offset:57344
    v_mfma_f32_16x16x32_bf16 v[212:215], v[232:235], v[124:127], v[212:215]
    ds_read_b64_tr_b16 v[226:227], v244 offset:57600
    s_waitcnt lgkmcnt(12)
    v_mfma_f32_16x16x32_bf16 v[216:219], v[236:239], v[120:123], v[216:219]
    ds_read_b64_tr_b16 v[228:229], v245 offset:57344
    v_mfma_f32_16x16x32_bf16 v[220:223], v[236:239], v[124:127], v[220:223]
    ds_read_b64_tr_b16 v[230:231], v245 offset:57600
    s_waitcnt lgkmcnt(10)
    v_mfma_f32_16x16x32_bf16 v[176:179], v[144:147], v[128:131], v[176:179]
    ds_read_b128 v[136:139], v6 offset:32768
    ds_read_b128 v[140:143], v6 offset:34816
    v_mfma_f32_16x16x32_bf16 v[180:183], v[144:147], v[132:135], v[180:183]
    ds_read_b64_tr_b16 v[160:161], v4 offset:53248
    ds_read_b64_tr_b16 v[162:163], v4 offset:53760
    s_waitcnt lgkmcnt(12)
    v_mfma_f32_16x16x32_bf16 v[184:187], v[148:151], v[128:131], v[184:187]
    ds_read_b64_tr_b16 v[164:165], v7 offset:53248
    v_mfma_f32_16x16x32_bf16 v[188:191], v[148:151], v[132:135], v[188:191]
    ds_read_b64_tr_b16 v[166:167], v7 offset:53760
    s_waitcnt lgkmcnt(12)
    v_mfma_f32_16x16x32_bf16 v[192:195], v[152:155], v[128:131], v[192:195]
    ds_read_b64_tr_b16 v[168:169], v8 offset:53248
    v_mfma_f32_16x16x32_bf16 v[196:199], v[152:155], v[132:135], v[196:199]
    ds_read_b64_tr_b16 v[170:171], v8 offset:53760
    s_waitcnt lgkmcnt(12)
    v_mfma_f32_16x16x32_bf16 v[200:203], v[156:159], v[128:131], v[200:203]
    ds_read_b64_tr_b16 v[172:173], v9 offset:53248
    v_mfma_f32_16x16x32_bf16 v[204:207], v[156:159], v[132:135], v[204:207]
    ds_read_b64_tr_b16 v[174:175], v9 offset:53760
    s_waitcnt lgkmcnt(12)
    v_mfma_f32_16x16x32_bf16 v[208:211], v[224:227], v[128:131], v[208:211]
    ds_read_b64_tr_b16 v[232:233], v244 offset:59392
    v_mfma_f32_16x16x32_bf16 v[212:215], v[224:227], v[132:135], v[212:215]
    ds_read_b64_tr_b16 v[234:235], v244 offset:59648
    s_waitcnt lgkmcnt(12)
    v_mfma_f32_16x16x32_bf16 v[216:219], v[228:231], v[128:131], v[216:219]
    ds_read_b64_tr_b16 v[236:237], v245 offset:59392
    v_mfma_f32_16x16x32_bf16 v[220:223], v[228:231], v[132:135], v[220:223]
    ds_read_b64_tr_b16 v[238:239], v245 offset:59648
    s_waitcnt lgkmcnt(10)
    v_mfma_f32_16x16x32_bf16 v[176:179], v[160:163], v[136:139], v[176:179]
    v_mfma_f32_16x16x32_bf16 v[180:183], v[160:163], v[140:143], v[180:183]
    s_waitcnt lgkmcnt(8)
    v_mfma_f32_16x16x32_bf16 v[184:187], v[164:167], v[136:139], v[184:187]
    v_mfma_f32_16x16x32_bf16 v[188:191], v[164:167], v[140:143], v[188:191]
    s_waitcnt lgkmcnt(6)
    v_mfma_f32_16x16x32_bf16 v[192:195], v[168:171], v[136:139], v[192:195]
    v_mfma_f32_16x16x32_bf16 v[196:199], v[168:171], v[140:143], v[196:199]
    s_waitcnt lgkmcnt(4)
    v_mfma_f32_16x16x32_bf16 v[200:203], v[172:175], v[136:139], v[200:203]
    v_mfma_f32_16x16x32_bf16 v[204:207], v[172:175], v[140:143], v[204:207]
    s_waitcnt lgkmcnt(2)
    v_mfma_f32_16x16x32_bf16 v[208:211], v[232:235], v[136:139], v[208:211]
    v_mfma_f32_16x16x32_bf16 v[212:215], v[232:235], v[140:143], v[212:215]
    s_waitcnt lgkmcnt(0)
    v_mfma_f32_16x16x32_bf16 v[216:219], v[236:239], v[136:139], v[216:219]
    v_mfma_f32_16x16x32_bf16 v[220:223], v[236:239], v[140:143], v[220:223]
    s_nop 3
    v_cvt_pk_bf16_f32 v144, v176, v177
    v_cvt_pk_bf16_f32 v145, v178, v179
    v_cvt_pk_bf16_f32 v146, v180, v181
    v_cvt_pk_bf16_f32 v147, v182, v183
    v_cvt_pk_bf16_f32 v148, v184, v185
    v_cvt_pk_bf16_f32 v149, v186, v187
    v_cvt_pk_bf16_f32 v150, v188, v189
    v_cvt_pk_bf16_f32 v151, v190, v191
    v_permlane16_swap_b32 v144, v146
    v_permlane16_swap_b32 v145, v147
    s_add_u32 s59, s70, 4194304
    buffer_store_dwordx4 v[144:147], v2, s[16:19], s59 offen sc1
    v_cvt_pk_bf16_f32 v152, v192, v193
    v_cvt_pk_bf16_f32 v153, v194, v195
    v_cvt_pk_bf16_f32 v154, v196, v197
    v_cvt_pk_bf16_f32 v155, v198, v199
    v_permlane16_swap_b32 v148, v150
    v_permlane16_swap_b32 v149, v151
    s_add_u32 s59, s70, 4325376
    buffer_store_dwordx4 v[148:151], v2, s[16:19], s59 offen sc1
    v_cvt_pk_bf16_f32 v156, v200, v201
    v_cvt_pk_bf16_f32 v157, v202, v203
    v_cvt_pk_bf16_f32 v158, v204, v205
    v_cvt_pk_bf16_f32 v159, v206, v207
    v_permlane16_swap_b32 v152, v154
    v_permlane16_swap_b32 v153, v155
    s_add_u32 s59, s70, 4456448
    buffer_store_dwordx4 v[152:155], v2, s[16:19], s59 offen sc1
    s_nop 1
    v_permlane16_swap_b32 v156, v158
    v_permlane16_swap_b32 v157, v159
    s_add_u32 s59, s70, 4587520
    buffer_store_dwordx4 v[156:159], v2, s[16:19], s59 offen sc1
    v_mov_b32 v250, 163776
    v_mov_b32 v251, 1
    s_mov_b64 exec, 1
    ds_add_u32 v250, v251 offset:4
    s_mov_b64 exec, -1
    s_setprio 3
    v_mul_f32 v208, s69, v208
    v_mul_f32 v209, s69, v209
    v_mul_f32 v210, s69, v210
    v_mul_f32 v211, s69, v211
    v_mul_f32 v212, s69, v212
    v_mul_f32 v213, s69, v213
    v_mul_f32 v214, s69, v214
    v_mul_f32 v215, s69, v215
    v_mul_f32 v216, s69, v216
    v_mul_f32 v217, s69, v217
    v_mul_f32 v218, s69, v218
    v_mul_f32 v219, s69, v219
    v_mul_f32 v220, s69, v220
    v_mul_f32 v221, s69, v221
    v_mul_f32 v222, s69, v222
    v_mul_f32 v223, s69, v223
    v_cvt_pk_bf16_f32 v208, v208, v209
    v_cvt_pk_bf16_f32 v209, v210, v211
    v_cvt_pk_bf16_f32 v210, v212, v213
    v_cvt_pk_bf16_f32 v211, v214, v215
    v_cvt_pk_bf16_f32 v212, v216, v217
    v_cvt_pk_bf16_f32 v213, v218, v219
    v_cvt_pk_bf16_f32 v214, v220, v221
    v_cvt_pk_bf16_f32 v215, v222, v223
    v_permlane16_swap_b32 v208, v210
    v_permlane16_swap_b32 v209, v211
    v_permlane16_swap_b32 v212, v214
    v_permlane16_swap_b32 v213, v215
    ds_write_b128 v248, v[208:211] offset:0
    ds_write_b128 v248, v[212:215] offset:4096
    s_waitcnt lgkmcnt(0)
    v_mov_b32 v250, 163776
    v_mov_b32 v251, 1
    s_mov_b64 exec, 1
    ds_add_u32 v250, v251 offset:56
    s_mov_b64 exec, -1
    ds_read_b128 v[176:179], v0 offset:0
    ds_read_b128 v[180:183], v0 offset:64
    ds_read_b128 v[184:187], v0 offset:128
    ds_read_b128 v[188:191], v0 offset:192
    ds_read_b128 v[192:195], v0 offset:256
    ds_read_b128 v[196:199], v0 offset:320
    ds_read_b128 v[200:203], v0 offset:384
    ds_read_b128 v[204:207], v0 offset:448
    s_waitcnt lgkmcnt(4)
    v_dot2c_f32_bf16 v14, v16, v176
    v_dot2c_f32_bf16 v15, v20, v176
    v_dot2c_f32_bf16 v10, v17, v177
    v_dot2c_f32_bf16 v11, v21, v177
    v_dot2c_f32_bf16 v14, v18, v178
    v_dot2c_f32_bf16 v15, v22, v178
    v_dot2c_f32_bf16 v10, v19, v179
    v_dot2c_f32_bf16 v11, v23, v179
    v_dot2c_f32_bf16 v14, v24, v180
    v_dot2c_f32_bf16 v15, v28, v180
    v_dot2c_f32_bf16 v10, v25, v181
    v_dot2c_f32_bf16 v11, v29, v181
    v_dot2c_f32_bf16 v14, v26, v182
    v_dot2c_f32_bf16 v15, v30, v182
    v_dot2c_f32_bf16 v10, v27, v183
    v_dot2c_f32_bf16 v11, v31, v183
    v_dot2c_f32_bf16 v14, v32, v184
    v_dot2c_f32_bf16 v15, v36, v184
    v_dot2c_f32_bf16 v10, v33, v185
    v_dot2c_f32_bf16 v11, v37, v185
    v_dot2c_f32_bf16 v14, v34, v186
    v_dot2c_f32_bf16 v15, v38, v186
    v_dot2c_f32_bf16 v10, v35, v187
    v_dot2c_f32_bf16 v11, v39, v187
    v_dot2c_f32_bf16 v14, v40, v188
    v_dot2c_f32_bf16 v15, v44, v188
    v_dot2c_f32_bf16 v10, v41, v189
    v_dot2c_f32_bf16 v11, v45, v189
    v_dot2c_f32_bf16 v14, v42, v190
    v_dot2c_f32_bf16 v15, v46, v190
    v_dot2c_f32_bf16 v10, v43, v191
    v_dot2c_f32_bf16 v11, v47, v191
    ds_read_b128 v[176:179], v0 offset:512
    ds_read_b128 v[180:183], v0 offset:576
    ds_read_b128 v[184:187], v0 offset:640
    ds_read_b128 v[188:191], v0 offset:704
    s_waitcnt lgkmcnt(4)
    v_dot2c_f32_bf16 v14, v48, v192
    v_dot2c_f32_bf16 v15, v52, v192
    v_dot2c_f32_bf16 v10, v49, v193
    v_dot2c_f32_bf16 v11, v53, v193
    v_dot2c_f32_bf16 v14, v50, v194
    v_dot2c_f32_bf16 v15, v54, v194
    v_dot2c_f32_bf16 v10, v51, v195
    v_dot2c_f32_bf16 v11, v55, v195
    v_dot2c_f32_bf16 v14, v56, v196
    v_dot2c_f32_bf16 v15, v60, v196
    v_dot2c_f32_bf16 v10, v57, v197
    v_dot2c_f32_bf16 v11, v61, v197
    v_dot2c_f32_bf16 v14, v58, v198
    v_dot2c_f32_bf16 v15, v62, v198
    v_dot2c_f32_bf16 v10, v59, v199
    v_dot2c_f32_bf16 v11, v63, v199
    v_dot2c_f32_bf16 v14, v64, v200
    v_dot2c_f32_bf16 v15, v68, v200
    v_dot2c_f32_bf16 v10, v65, v201
    v_dot2c_f32_bf16 v11, v69, v201
    v_dot2c_f32_bf16 v14, v66, v202
    v_dot2c_f32_bf16 v15, v70, v202
    v_dot2c_f32_bf16 v10, v67, v203
    v_dot2c_f32_bf16 v11, v71, v203
    v_dot2c_f32_bf16 v14, v72, v204
    v_dot2c_f32_bf16 v15, v76, v204
    v_dot2c_f32_bf16 v10, v73, v205
    v_dot2c_f32_bf16 v11, v77, v205
    v_dot2c_f32_bf16 v14, v74, v206
    v_dot2c_f32_bf16 v15, v78, v206
    v_dot2c_f32_bf16 v10, v75, v207
    v_dot2c_f32_bf16 v11, v79, v207
    ds_read_b128 v[192:195], v0 offset:768
    ds_read_b128 v[196:199], v0 offset:832
    ds_read_b128 v[200:203], v0 offset:896
    ds_read_b128 v[204:207], v0 offset:960
    s_waitcnt lgkmcnt(4)
    v_dot2c_f32_bf16 v14, v80, v176
    v_dot2c_f32_bf16 v15, v84, v176
    v_dot2c_f32_bf16 v10, v81, v177
    v_dot2c_f32_bf16 v11, v85, v177
    v_dot2c_f32_bf16 v14, v82, v178
    v_dot2c_f32_bf16 v15, v86, v178
    v_dot2c_f32_bf16 v10, v83, v179
    v_dot2c_f32_bf16 v11, v87, v179
    v_dot2c_f32_bf16 v14, v88, v180
    v_dot2c_f32_bf16 v15, v92, v180
    v_dot2c_f32_bf16 v10, v89, v181
    v_dot2c_f32_bf16 v11, v93, v181
    v_dot2c_f32_bf16 v14, v90, v182
    v_dot2c_f32_bf16 v15, v94, v182
    v_dot2c_f32_bf16 v10, v91, v183
    v_dot2c_f32_bf16 v11, v95, v183
    v_dot2c_f32_bf16 v14, v96, v184
    v_dot2c_f32_bf16 v15, v100, v184
    v_dot2c_f32_bf16 v10, v97, v185
    v_dot2c_f32_bf16 v11, v101, v185
    v_dot2c_f32_bf16 v14, v98, v186
    v_dot2c_f32_bf16 v15, v102, v186
    v_dot2c_f32_bf16 v10, v99, v187
    v_dot2c_f32_bf16 v11, v103, v187
    v_dot2c_f32_bf16 v14, v104, v188
    v_dot2c_f32_bf16 v15, v108, v188
    v_dot2c_f32_bf16 v10, v105, v189
    v_dot2c_f32_bf16 v11, v109, v189
    v_dot2c_f32_bf16 v14, v106, v190
    v_dot2c_f32_bf16 v15, v110, v190
    v_dot2c_f32_bf16 v10, v107, v191
    v_dot2c_f32_bf16 v11, v111, v191
    s_waitcnt lgkmcnt(0)
    v_dot2c_f32_bf16 v14, v112, v192
    v_dot2c_f32_bf16 v15, v116, v192
    v_dot2c_f32_bf16 v10, v113, v193
    v_dot2c_f32_bf16 v11, v117, v193
    v_dot2c_f32_bf16 v14, v114, v194
    v_dot2c_f32_bf16 v15, v118, v194
    v_dot2c_f32_bf16 v10, v115, v195
    v_dot2c_f32_bf16 v11, v119, v195
    v_dot2c_f32_bf16 v14, v120, v196
    v_dot2c_f32_bf16 v15, v124, v196
    v_dot2c_f32_bf16 v10, v121, v197
    v_dot2c_f32_bf16 v11, v125, v197
    v_dot2c_f32_bf16 v14, v122, v198
    v_dot2c_f32_bf16 v15, v126, v198
    v_dot2c_f32_bf16 v10, v123, v199
    v_dot2c_f32_bf16 v11, v127, v199
    v_dot2c_f32_bf16 v14, v128, v200
    v_dot2c_f32_bf16 v15, v132, v200
    v_dot2c_f32_bf16 v10, v129, v201
    v_dot2c_f32_bf16 v11, v133, v201
    v_dot2c_f32_bf16 v14, v130, v202
    v_dot2c_f32_bf16 v15, v134, v202
    v_dot2c_f32_bf16 v10, v131, v203
    v_dot2c_f32_bf16 v11, v135, v203
    v_dot2c_f32_bf16 v14, v136, v204
    v_dot2c_f32_bf16 v15, v140, v204
    v_dot2c_f32_bf16 v10, v137, v205
    v_dot2c_f32_bf16 v11, v141, v205
    v_dot2c_f32_bf16 v14, v138, v206
    v_dot2c_f32_bf16 v15, v142, v206
    v_dot2c_f32_bf16 v10, v139, v207
    v_dot2c_f32_bf16 v11, v143, v207
    v_and_b32 v5, 31, v1
    s_lshl_b32 s59, s68, 7
    s_add_u32 s59, s59, 154624
    v_lshl_add_u32 v5, v5, 2, s59
    v_add_f32 v14, v14, v10
    v_add_f32 v15, v15, v11
    s_nop 1
    v_permlane16_swap_b32 v14, v15
    s_nop 1
    v_add_f32 v14, v14, v15
    v_mov_b32 v15, v14
    s_nop 1
    v_permlane32_swap_b32 v14, v15
    s_nop 1
    v_add_f32 v14, v14, v15
    v_mul_f32 v14, 0xbfb8aa3b, v14
    v_exp_f32 v14, v14
    s_nop 0
    v_add_f32 v14, 1.0, v14
    v_rcp_f32 v14, v14
    s_nop 0
    ds_write_b32 v5, v14
    s_waitcnt lgkmcnt(0)
    s_waitcnt vmcnt(0)
    s_mov_b32 s59, 262144
L_tag_3:
    v_cmp_eq_u32 vcc, 0, v255
    s_cbranch_vccz L_tag_3_ok
    buffer_load_dwordx2 v[254:255], v249, s[20:23], 0 offen sc1
    s_waitcnt vmcnt(0)
    s_sleep 1
    s_sub_u32 s59, s59, 1
    s_cmp_lg_u32 s59, 0
    s_cbranch_scc1 L_tag_3
L_tag_3_ok:
    v_readfirstlane_b32 s30, v254
    v_readfirstlane_b32 s31, v255
    v_mov_b32 v250, 163776
    v_mov_b32 v251, 1
    s_mov_b64 exec, 1
    ds_add_rtn_u32 v251, v250, v251 offset:0
    s_lshl_b32 s60, s55, 5
    s_add_u32 s60, s60, s3
    s_lshl_b32 s60, s60, 7
    s_add_u32 s60, s60, 17039360
    s_waitcnt lgkmcnt(0)
    v_readfirstlane_b32 s59, v251
    s_mov_b64 exec, 0xff
    v_mov_b32 v252, s30
    v_mov_b32 v253, s31
    v_mov_b32 v254, s30
    v_mov_b32 v255, s31
    s_cmp_lg_u32 s59, 3
    s_cbranch_scc1 L_pub_4
    buffer_store_dwordx4 v[252:255], v2, s[16:19], s60 offen sc1
L_pub_4:
    s_mov_b64 exec, -1
    v_and_b32 v250, 3, v1
    v_lshlrev_b32 v250, 2, v250
    v_add_u32 v250, 163776, v250
    s_mov_b32 s59, 2097152
L_lw_5:
    ds_read_b32 v251, v250 offset:16
    s_waitcnt lgkmcnt(0)
    v_cmp_gt_u32 vcc, 2, v251
    s_cbranch_vccz L_lw_5_ok
    s_sleep 1
    s_sub_u32 s59, s59, 1
    s_cmp_lg_u32 s59, 0
    s_cbranch_scc1 L_lw_5
L_lw_5_ok:
    v_xor_b32 v4, 0x10000, v4
    v_xor_b32 v7, 0x10000, v7
    v_xor_b32 v8, 0x10000, v8
    v_xor_b32 v9, 0x10000, v9
    v_xor_b32 v244, 0x10000, v244
    v_xor_b32 v245, 0x10000, v245
    ds_read_b64_tr_b16 v[144:145], v4 offset:0
    ds_read_b64_tr_b16 v[146:147], v4 offset:512
    ds_read_b64_tr_b16 v[148:149], v7 offset:0
    ds_read_b64_tr_b16 v[150:151], v7 offset:512
    ds_read_b64_tr_b16 v[152:153], v8 offset:0
    ds_read_b64_tr_b16 v[154:155], v8 offset:512
    ds_read_b64_tr_b16 v[156:157], v9 offset:0
    ds_read_b64_tr_b16 v[158:159], v9 offset:512
    ds_read_b64_tr_b16 v[224:225], v244 offset:28672
    ds_read_b64_tr_b16 v[226:227], v244 offset:28928
    ds_read_b64_tr_b16 v[228:229], v245 offset:28672
    ds_read_b64_tr_b16 v[230:231], v245 offset:28928
    s_waitcnt lgkmcnt(10)
    v_mfma_f32_16x16x32_bf16 v[176:179], v[144:147], v[16:19], 0
    ds_read_b64_tr_b16 v[160:161], v4 offset:4096
    v_mfma_f32_16x16x32_bf16 v[180:183], v[144:147], v[20:23], 0
    ds_read_b64_tr_b16 v[162:163], v4 offset:4608
    s_waitcnt lgkmcnt(10)
    v_mfma_f32_16x16x32_bf16 v[184:187], v[148:151], v[16:19], 0
    ds_read_b64_tr_b16 v[164:165], v7 offset:4096
    v_mfma_f32_16x16x32_bf16 v[188:191], v[148:151], v[20:23], 0
    ds_read_b64_tr_b16 v[166:167], v7 offset:4608
    s_waitcnt lgkmcnt(10)
    v_mfma_f32_16x16x32_bf16 v[192:195], v[152:155], v[16:19], 0
    ds_read_b64_tr_b16 v[168:169], v8 offset:4096
    v_mfma_f32_16x16x32_bf16 v[196:199], v[152:155], v[20:23], 0
    ds_read_b64_tr_b16 v[170:171], v8 offset:4608
    s_waitcnt lgkmcnt(10)
    v_mfma_f32_16x16x32_bf16 v[200:203], v[156:159], v[16:19], 0
    ds_read_b64_tr_b16 v[172:173], v9 offset:4096
    v_mfma_f32_16x16x32_bf16 v[204:207], v[156:159], v[20:23], 0
    ds_read_b64_tr_b16 v[174:175], v9 offset:4608
    s_waitcnt lgkmcnt(10)
    v_mfma_f32_16x16x32_bf16 v[208:211], v[224:227], v[16:19], 0
    ds_read_b64_tr_b16 v[232:233], v244 offset:30720
    v_mfma_f32_16x16x32_bf16 v[212:215], v[224:227], v[20:23], 0
    ds_read_b64_tr_b16 v[234:235], v244 offset:30976
    s_waitcnt lgkmcnt(10)
    v_mfma_f32_16x16x32_bf16 v[216:219], v[228:231], v[16:19], 0
    ds_read_b64_tr_b16 v[236:237], v245 offset:30720
    v_mfma_f32_16x16x32_bf16 v[220:223], v[228:231], v[20:23], 0
    ds_read_b64_tr_b16 v[238:239], v245 offset:30976
    s_waitcnt lgkmcnt(10)
    v_mfma_f32_16x16x32_bf16 v[176:179], v[160:163], v[24:27], v[176:179]
    ds_read_b64_tr_b16 v[144:145], v4 offset:8192
    v_mfma_f32_16x16x32_bf16 v[180:183], v[160:163], v[28:31], v[180:183]
    ds_read_b64_tr_b16 v[146:147], v4 offset:8704
    s_waitcnt lgkmcnt(10)
    v_mfma_f32_16x16x32_bf16 v[184:187], v[164:167], v[24:27], v[184:187]
    ds_read_b64_tr_b16 v[148:149], v7 offset:8192
    v_mfma_f32_16x16x32_bf16 v[188:191], v[164:167], v[28:31], v[188:191]
    ds_read_b64_tr_b16 v[150:151], v7 offset:8704
    s_waitcnt lgkmcnt(10)
    v_mfma_f32_16x16x32_bf16 v[192:195], v[168:171], v[24:27], v[192:195]
    ds_read_b64_tr_b16 v[152:153], v8 offset:8192
    v_mfma_f32_16x16x32_bf16 v[196:199], v[168:171], v[28:31], v[196:199]
    ds_read_b64_tr_b16 v[154:155], v8 offset:8704
    s_waitcnt lgkmcnt(10)
    v_mfma_f32_16x16x32_bf16 v[200:203], v[172:175], v[24:27], v[200:203]
    ds_read_b64_tr_b16 v[156:157], v9 offset:8192
    v_mfma_f32_16x16x32_bf16 v[204:207], v[172:175], v[28:31], v[204:207]
    ds_read_b64_tr_b16 v[158:159], v9 offset:8704
    s_waitcnt lgkmcnt(10)
    v_mfma_f32_16x16x32_bf16 v[208:211], v[232:235], v[24:27], v[208:211]
    ds_read_b64_tr_b16 v[224:225], v244 offset:61440
    v_mfma_f32_16x16x32_bf16 v[212:215], v[232:235], v[28:31], v[212:215]
    ds_read_b64_tr_b16 v[226:227], v244 offset:61696
    s_waitcnt lgkmcnt(10)
    v_mfma_f32_16x16x32_bf16 v[216:219], v[236:239], v[24:27], v[216:219]
    ds_read_b64_tr_b16 v[228:229], v245 offset:61440
    v_mfma_f32_16x16x32_bf16 v[220:223], v[236:239], v[28:31], v[220:223]
    ds_read_b64_tr_b16 v[230:231], v245 offset:61696
    s_waitcnt lgkmcnt(10)
    v_mfma_f32_16x16x32_bf16 v[176:179], v[144:147], v[32:35], v[176:179]
    ds_read_b64_tr_b16 v[160:161], v4 offset:12288
    v_mfma_f32_16x16x32_bf16 v[180:183], v[144:147], v[36:39], v[180:183]
    ds_read_b64_tr_b16 v[162:163], v4 offset:12800
    s_waitcnt lgkmcnt(10)
    v_mfma_f32_16x16x32_bf16 v[184:187], v[148:151], v[32:35], v[184:187]
    ds_read_b64_tr_b16 v[164:165], v7 offset:12288
    v_mfma_f32_16x16x32_bf16 v[188:191], v[148:151], v[36:39], v[188:191]
    ds_read_b64_tr_b16 v[166:167], v7 offset:12800
    s_waitcnt lgkmcnt(10)
    v_mfma_f32_16x16x32_bf16 v[192:195], v[152:155], v[32:35], v[192:195]
    ds_read_b64_tr_b16 v[168:169], v8 offset:12288
    v_mfma_f32_16x16x32_bf16 v[196:199], v[152:155], v[36:39], v[196:199]
    ds_read_b64_tr_b16 v[170:171], v8 offset:12800
    s_waitcnt lgkmcnt(10)
    v_mfma_f32_16x16x32_bf16 v[200:203], v[156:159], v[32:35], v[200:203]
    ds_read_b64_tr_b16 v[172:173], v9 offset:12288
    v_mfma_f32_16x16x32_bf16 v[204:207], v[156:159], v[36:39], v[204:207]
    ds_read_b64_tr_b16 v[174:175], v9 offset:12800
    s_waitcnt lgkmcnt(10)
    v_mfma_f32_16x16x32_bf16 v[208:211], v[224:227], v[32:35], v[208:211]
    ds_read_b64_tr_b16 v[232:233], v244 offset:63488
    v_mfma_f32_16x16x32_bf16 v[212:215], v[224:227], v[36:39], v[212:215]
    ds_read_b64_tr_b16 v[234:235], v244 offset:63744
    s_waitcnt lgkmcnt(10)
    v_mfma_f32_16x16x32_bf16 v[216:219], v[228:231], v[32:35], v[216:219]
    ds_read_b64_tr_b16 v[236:237], v245 offset:63488
    v_mfma_f32_16x16x32_bf16 v[220:223], v[228:231], v[36:39], v[220:223]
    ds_read_b64_tr_b16 v[238:239], v245 offset:63744
    s_waitcnt lgkmcnt(10)
    v_mfma_f32_16x16x32_bf16 v[176:179], v[160:163], v[40:43], v[176:179]
    v_xor_b32 v244, 0x10000, v244
    v_xor_b32 v245, 0x10000, v245
    ds_read_b64_tr_b16 v[144:145], v4 offset:16384
    v_mfma_f32_16x16x32_bf16 v[180:183], v[160:163], v[44:47], v[180:183]
    ds_read_b64_tr_b16 v[146:147], v4 offset:16896
    s_waitcnt lgkmcnt(10)
    v_mfma_f32_16x16x32_bf16 v[184:187], v[164:167], v[40:43], v[184:187]
    ds_read_b64_tr_b16 v[148:149], v7 offset:16384
    v_mfma_f32_16x16x32_bf16 v[188:191], v[164:167], v[44:47], v[188:191]
    ds_read_b64_tr_b16 v[150:151], v7 offset:16896
    s_waitcnt lgkmcnt(10)
    v_mfma_f32_16x16x32_bf16 v[192:195], v[168:171], v[40:43], v[192:195]
    ds_read_b64_tr_b16 v[152:153], v8 offset:16384
    v_mfma_f32_16x16x32_bf16 v[196:199], v[168:171], v[44:47], v[196:199]
    ds_read_b64_tr_b16 v[154:155], v8 offset:16896
    s_waitcnt lgkmcnt(10)
    v_mfma_f32_16x16x32_bf16 v[200:203], v[172:175], v[40:43], v[200:203]
    ds_read_b64_tr_b16 v[156:157], v9 offset:16384
    v_mfma_f32_16x16x32_bf16 v[204:207], v[172:175], v[44:47], v[204:207]
    ds_read_b64_tr_b16 v[158:159], v9 offset:16896
    s_waitcnt lgkmcnt(10)
    v_mfma_f32_16x16x32_bf16 v[208:211], v[232:235], v[40:43], v[208:211]
    ds_read_b64_tr_b16 v[224:225], v244 offset:28672
    v_mfma_f32_16x16x32_bf16 v[212:215], v[232:235], v[44:47], v[212:215]
    ds_read_b64_tr_b16 v[226:227], v244 offset:28928
    s_waitcnt lgkmcnt(10)
    v_mfma_f32_16x16x32_bf16 v[216:219], v[236:239], v[40:43], v[216:219]
    ds_read_b64_tr_b16 v[228:229], v245 offset:28672
    v_mfma_f32_16x16x32_bf16 v[220:223], v[236:239], v[44:47], v[220:223]
    ds_read_b64_tr_b16 v[230:231], v245 offset:28928
    s_waitcnt lgkmcnt(10)
    v_mfma_f32_16x16x32_bf16 v[176:179], v[144:147], v[48:51], v[176:179]
    ds_read_b64_tr_b16 v[160:161], v4 offset:20480
    v_mfma_f32_16x16x32_bf16 v[180:183], v[144:147], v[52:55], v[180:183]
    ds_read_b64_tr_b16 v[162:163], v4 offset:20992
    s_waitcnt lgkmcnt(10)
    v_mfma_f32_16x16x32_bf16 v[184:187], v[148:151], v[48:51], v[184:187]
    ds_read_b64_tr_b16 v[164:165], v7 offset:20480
    v_mfma_f32_16x16x32_bf16 v[188:191], v[148:151], v[52:55], v[188:191]
    ds_read_b64_tr_b16 v[166:167], v7 offset:20992
    s_waitcnt lgkmcnt(10)
    v_mfma_f32_16x16x32_bf16 v[192:195], v[152:155], v[48:51], v[192:195]
    ds_read_b64_tr_b16 v[168:169], v8 offset:20480
    v_mfma_f32_16x16x32_bf16 v[196:199], v[152:155], v[52:55], v[196:199]
    ds_read_b64_tr_b16 v[170:171], v8 offset:20992
    s_waitcnt lgkmcnt(10)
    v_mfma_f32_16x16x32_bf16 v[200:203], v[156:159], v[48:51], v[200:203]
    ds_read_b64_tr_b16 v[172:173], v9 offset:20480
    v_mfma_f32_16x16x32_bf16 v[204:207], v[156:159], v[52:55], v[204:207]
    ds_read_b64_tr_b16 v[174:175], v9 offset:20992
    s_waitcnt lgkmcnt(10)
    v_mfma_f32_16x16x32_bf16 v[208:211], v[224:227], v[48:51], v[208:211]
    ds_read_b64_tr_b16 v[232:233], v244 offset:30720
    v_mfma_f32_16x16x32_bf16 v[212:215], v[224:227], v[52:55], v[212:215]
    ds_read_b64_tr_b16 v[234:235], v244 offset:30976
    s_waitcnt lgkmcnt(10)
    v_mfma_f32_16x16x32_bf16 v[216:219], v[228:231], v[48:51], v[216:219]
    ds_read_b64_tr_b16 v[236:237], v245 offset:30720
    v_mfma_f32_16x16x32_bf16 v[220:223], v[228:231], v[52:55], v[220:223]
    ds_read_b64_tr_b16 v[238:239], v245 offset:30976
    s_waitcnt lgkmcnt(10)
    v_mfma_f32_16x16x32_bf16 v[176:179], v[160:163], v[56:59], v[176:179]
    v_and_b32 v250, 3, v1
    v_lshlrev_b32 v250, 2, v250
    v_add_u32 v250, 163776, v250
    s_mov_b32 s59, 2097152
L_lw_6:
    ds_read_b32 v251, v250 offset:16
    s_waitcnt lgkmcnt(0)
    v_cmp_gt_u32 vcc, 3, v251
    s_cbranch_vccz L_lw_6_ok
    s_sleep 1
    s_sub_u32 s59, s59, 1
    s_cmp_lg_u32 s59, 0
    s_cbranch_scc1 L_lw_6
L_lw_6_ok:
    ds_read_b64_tr_b16 v[144:145], v4 offset:32768
    v_mfma_f32_16x16x32_bf16 v[180:183], v[160:163], v[60:63], v[180:183]
    ds_read_b64_tr_b16 v[146:147], v4 offset:33280
    s_waitcnt lgkmcnt(10)
    v_mfma_f32_16x16x32_bf16 v[184:187], v[164:167], v[56:59], v[184:187]
    ds_read_b64_tr_b16 v[148:149], v7 offset:32768
    v_mfma_f32_16x16x32_bf16 v[188:191], v[164:167], v[60:63], v[188:191]
    ds_read_b64_tr_b16 v[150:151], v7 offset:33280
    s_waitcnt lgkmcnt(10)
    v_mfma_f32_16x16x32_bf16 v[192:195], v[168:171], v[56:59], v[192:195]
    ds_read_b64_tr_b16 v[152:153], v8 offset:32768
    v_mfma_f32_16x16x32_bf16 v[196:199], v[168:171], v[60:63], v[196:199]
    ds_read_b64_tr_b16 v[154:155], v8 offset:33280
    s_waitcnt lgkmcnt(10)
    v_mfma_f32_16x16x32_bf16 v[200:203], v[172:175], v[56:59], v[200:203]
    ds_read_b64_tr_b16 v[156:157], v9 offset:32768
    v_mfma_f32_16x16x32_bf16 v[204:207], v[172:175], v[60:63], v[204:207]
    ds_read_b64_tr_b16 v[158:159], v9 offset:33280
    s_waitcnt lgkmcnt(10)
    v_mfma_f32_16x16x32_bf16 v[208:211], v[232:235], v[56:59], v[208:211]
    ds_read_b64_tr_b16 v[224:225], v244 offset:61440
    v_mfma_f32_16x16x32_bf16 v[212:215], v[232:235], v[60:63], v[212:215]
    ds_read_b64_tr_b16 v[226:227], v244 offset:61696
    s_waitcnt lgkmcnt(10)
    v_mfma_f32_16x16x32_bf16 v[216:219], v[236:239], v[56:59], v[216:219]
    ds_read_b64_tr_b16 v[228:229], v245 offset:61440
    v_mfma_f32_16x16x32_bf16 v[220:223], v[236:239], v[60:63], v[220:223]
    ds_read_b64_tr_b16 v[230:231], v245 offset:61696
    s_waitcnt lgkmcnt(10)
    v_mfma_f32_16x16x32_bf16 v[176:179], v[144:147], v[64:67], v[176:179]
    ds_read_b64_tr_b16 v[160:161], v4 offset:36864
    v_mfma_f32_16x16x32_bf16 v[180:183], v[144:147], v[68:71], v[180:183]
    ds_read_b64_tr_b16 v[162:163], v4 offset:37376
    s_waitcnt lgkmcnt(10)
    v_mfma_f32_16x16x32_bf16 v[184:187], v[148:151], v[64:67], v[184:187]
    ds_read_b64_tr_b16 v[164:165], v7 offset:36864
    v_mfma_f32_16x16x32_bf16 v[188:191], v[148:151], v[68:71], v[188:191]
    ds_read_b64_tr_b16 v[166:167], v7 offset:37376
    s_waitcnt lgkmcnt(10)
    v_mfma_f32_16x16x32_bf16 v[192:195], v[152:155], v[64:67], v[192:195]
    ds_read_b64_tr_b16 v[168:169], v8 offset:36864
    v_mfma_f32_16x16x32_bf16 v[196:199], v[152:155], v[68:71], v[196:199]
    ds_read_b64_tr_b16 v[170:171], v8 offset:37376
    s_waitcnt lgkmcnt(10)
    v_mfma_f32_16x16x32_bf16 v[200:203], v[156:159], v[64:67], v[200:203]
    ds_read_b64_tr_b16 v[172:173], v9 offset:36864
    v_mfma_f32_16x16x32_bf16 v[204:207], v[156:159], v[68:71], v[204:207]
    ds_read_b64_tr_b16 v[174:175], v9 offset:37376
    s_waitcnt lgkmcnt(10)
    v_mfma_f32_16x16x32_bf16 v[208:211], v[224:227], v[64:67], v[208:211]
    ds_read_b64_tr_b16 v[232:233], v244 offset:63488
    v_mfma_f32_16x16x32_bf16 v[212:215], v[224:227], v[68:71], v[212:215]
    ds_read_b64_tr_b16 v[234:235], v244 offset:63744
    s_waitcnt lgkmcnt(10)
    v_mfma_f32_16x16x32_bf16 v[216:219], v[228:231], v[64:67], v[216:219]
    ds_read_b64_tr_b16 v[236:237], v245 offset:63488
    v_mfma_f32_16x16x32_bf16 v[220:223], v[228:231], v[68:71], v[220:223]
    ds_read_b64_tr_b16 v[238:239], v245 offset:63744
    s_waitcnt lgkmcnt(10)
    v_mfma_f32_16x16x32_bf16 v[176:179], v[160:163], v[72:75], v[176:179]
    v_xor_b32 v244, 0x10000, v244
    v_xor_b32 v245, 0x10000, v245
    ds_read_b64_tr_b16 v[144:145], v4 offset:40960
    v_mfma_f32_16x16x32_bf16 v[180:183], v[160:163], v[76:79], v[180:183]
    ds_read_b64_tr_b16 v[146:147], v4 offset:41472
    s_waitcnt lgkmcnt(10)
    v_mfma_f32_16x16x32_bf16 v[184:187], v[164:167], v[72:75], v[184:187]
    ds_read_b64_tr_b16 v[148:149], v7 offset:40960
    v_mfma_f32_16x16x32_bf16 v[188:191], v[164:167], v[76:79], v[188:191]
    ds_read_b64_tr_b16 v[150:151], v7 offset:41472
    s_waitcnt lgkmcnt(10)
    v_mfma_f32_16x16x32_bf16 v[192:195], v[168:171], v[72:75], v[192:195]
    ds_read_b64_tr_b16 v[152:153], v8 offset:40960
    v_mfma_f32_16x16x32_bf16 v[196:199], v[168:171], v[76:79], v[196:199]
    ds_read_b64_tr_b16 v[154:155], v8 offset:41472
    s_waitcnt lgkmcnt(10)
    v_mfma_f32_16x16x32_bf16 v[200:203], v[172:175], v[72:75], v[200:203]
    ds_read_b64_tr_b16 v[156:157], v9 offset:40960
    v_mfma_f32_16x16x32_bf16 v[204:207], v[172:175], v[76:79], v[204:207]
    ds_read_b64_tr_b16 v[158:159], v9 offset:41472
    s_waitcnt lgkmcnt(10)
    v_mfma_f32_16x16x32_bf16 v[208:211], v[232:235], v[72:75], v[208:211]
    ds_read_b64_tr_b16 v[224:225], v244 offset:24576
    v_mfma_f32_16x16x32_bf16 v[212:215], v[232:235], v[76:79], v[212:215]
    ds_read_b64_tr_b16 v[226:227], v244 offset:24832
    s_waitcnt lgkmcnt(10)
    v_mfma_f32_16x16x32_bf16 v[216:219], v[236:239], v[72:75], v[216:219]
    ds_read_b64_tr_b16 v[228:229], v245 offset:24576
    v_mfma_f32_16x16x32_bf16 v[220:223], v[236:239], v[76:79], v[220:223]
    ds_read_b64_tr_b16 v[230:231], v245 offset:24832
    s_waitcnt lgkmcnt(10)
    v_mfma_f32_16x16x32_bf16 v[176:179], v[144:147], v[80:83], v[176:179]
    ds_read_b64_tr_b16 v[160:161], v4 offset:45056
    v_mfma_f32_16x16x32_bf16 v[180:183], v[144:147], v[84:87], v[180:183]
    ds_read_b64_tr_b16 v[162:163], v4 offset:45568
    s_waitcnt lgkmcnt(10)
    v_mfma_f32_16x16x32_bf16 v[184:187], v[148:151], v[80:83], v[184:187]
    ds_read_b64_tr_b16 v[164:165], v7 offset:45056
    v_mfma_f32_16x16x32_bf16 v[188:191], v[148:151], v[84:87], v[188:191]
    ds_read_b64_tr_b16 v[166:167], v7 offset:45568
    s_waitcnt lgkmcnt(10)
    v_mfma_f32_16x16x32_bf16 v[192:195], v[152:155], v[80:83], v[192:195]
    ds_read_b64_tr_b16 v[168:169], v8 offset:45056
    v_mfma_f32_16x16x32_bf16 v[196:199], v[152:155], v[84:87], v[196:199]
    ds_read_b64_tr_b16 v[170:171], v8 offset:45568
    s_waitcnt lgkmcnt(10)
    v_mfma_f32_16x16x32_bf16 v[200:203], v[156:159], v[80:83], v[200:203]
    ds_read_b64_tr_b16 v[172:173], v9 offset:45056
    v_mfma_f32_16x16x32_bf16 v[204:207], v[156:159], v[84:87], v[204:207]
    ds_read_b64_tr_b16 v[174:175], v9 offset:45568
    s_waitcnt lgkmcnt(10)
    v_mfma_f32_16x16x32_bf16 v[208:211], v[224:227], v[80:83], v[208:211]
    ds_read_b64_tr_b16 v[232:233], v244 offset:26624
    v_mfma_f32_16x16x32_bf16 v[212:215], v[224:227], v[84:87], v[212:215]
    ds_read_b64_tr_b16 v[234:235], v244 offset:26880
    s_waitcnt lgkmcnt(10)
    v_mfma_f32_16x16x32_bf16 v[216:219], v[228:231], v[80:83], v[216:219]
    ds_read_b64_tr_b16 v[236:237], v245 offset:26624
    v_mfma_f32_16x16x32_bf16 v[220:223], v[228:231], v[84:87], v[220:223]
    ds_read_b64_tr_b16 v[238:239], v245 offset:26880
    s_waitcnt lgkmcnt(10)
    v_mfma_f32_16x16x32_bf16 v[176:179], v[160:163], v[88:91], v[176:179]
    ds_read_b64_tr_b16 v[144:145], v4 offset:49152
    v_mfma_f32_16x16x32_bf16 v[180:183], v[160:163], v[92:95], v[180:183]
    ds_read_b64_tr_b16 v[146:147], v4 offset:49664
    s_waitcnt lgkmcnt(10)
    v_mfma_f32_16x16x32_bf16 v[184:187], v[164:167], v[88:91], v[184:187]
    ds_read_b64_tr_b16 v[148:149], v7 offset:49152
    v_mfma_f32_16x16x32_bf16 v[188:191], v[164:167], v[92:95], v[188:191]
    ds_read_b64_tr_b16 v[150:151], v7 offset:49664
    s_waitcnt lgkmcnt(10)
    v_mfma_f32_16x16x32_bf16 v[192:195], v[168:171], v[88:91], v[192:195]
    ds_read_b64_tr_b16 v[152:153], v8 offset:49152
    v_mfma_f32_16x16x32_bf16 v[196:199], v[168:171], v[92:95], v[196:199]
    ds_read_b64_tr_b16 v[154:155], v8 offset:49664
    s_waitcnt lgkmcnt(10)
    v_mfma_f32_16x16x32_bf16 v[200:203], v[172:175], v[88:91], v[200:203]
    ds_read_b64_tr_b16 v[156:157], v9 offset:49152
    v_mfma_f32_16x16x32_bf16 v[204:207], v[172:175], v[92:95], v[204:207]
    ds_read_b64_tr_b16 v[158:159], v9 offset:49664
    s_waitcnt lgkmcnt(10)
    v_mfma_f32_16x16x32_bf16 v[208:211], v[232:235], v[88:91], v[208:211]
    ds_read_b64_tr_b16 v[224:225], v244 offset:57344
    v_mfma_f32_16x16x32_bf16 v[212:215], v[232:235], v[92:95], v[212:215]
    ds_read_b64_tr_b16 v[226:227], v244 offset:57600
    s_waitcnt lgkmcnt(10)
    v_mfma_f32_16x16x32_bf16 v[216:219], v[236:239], v[88:91], v[216:219]
    ds_read_b64_tr_b16 v[228:229], v245 offset:57344
    v_mfma_f32_16x16x32_bf16 v[220:223], v[236:239], v[92:95], v[220:223]
    ds_read_b64_tr_b16 v[230:231], v245 offset:57600
    s_waitcnt lgkmcnt(10)
    v_mfma_f32_16x16x32_bf16 v[176:179], v[144:147], v[96:99], v[176:179]
    ds_read_b64_tr_b16 v[160:161], v4 offset:53248
    v_mfma_f32_16x16x32_bf16 v[180:183], v[144:147], v[100:103], v[180:183]
    ds_read_b64_tr_b16 v[162:163], v4 offset:53760
    s_waitcnt lgkmcnt(10)
    v_mfma_f32_16x16x32_bf16 v[184:187], v[148:151], v[96:99], v[184:187]
    ds_read_b64_tr_b16 v[164:165], v7 offset:53248
    v_mfma_f32_16x16x32_bf16 v[188:191], v[148:151], v[100:103], v[188:191]
    ds_read_b64_tr_b16 v[166:167], v7 offset:53760
    s_waitcnt lgkmcnt(10)
    v_mfma_f32_16x16x32_bf16 v[192:195], v[152:155], v[96:99], v[192:195]
    ds_read_b64_tr_b16 v[168:169], v8 offset:53248
    v_mfma_f32_16x16x32_bf16 v[196:199], v[152:155], v[100:103], v[196:199]
    ds_read_b64_tr_b16 v[170:171], v8 offset:53760
    s_waitcnt lgkmcnt(10)
    v_mfma_f32_16x16x32_bf16 v[200:203], v[156:159], v[96:99], v[200:203]
    ds_read_b64_tr_b16 v[172:173], v9 offset:53248
    v_mfma_f32_16x16x32_bf16 v[204:207], v[156:159], v[100:103], v[204:207]
    ds_read_b64_tr_b16 v[174:175], v9 offset:53760
    s_waitcnt lgkmcnt(10)
    v_mfma_f32_16x16x32_bf16 v[208:211], v[224:227], v[96:99], v[208:211]
    ds_read_b64_tr_b16 v[232:233], v244 offset:59392
    v_mfma_f32_16x16x32_bf16 v[212:215], v[224:227], v[100:103], v[212:215]
    ds_read_b64_tr_b16 v[234:235], v244 offset:59648
    s_waitcnt lgkmcnt(10)
    v_mfma_f32_16x16x32_bf16 v[216:219], v[228:231], v[96:99], v[216:219]
    ds_read_b64_tr_b16 v[236:237], v245 offset:59392
    v_mfma_f32_16x16x32_bf16 v[220:223], v[228:231], v[100:103], v[220:223]
    ds_read_b64_tr_b16 v[238:239], v245 offset:59648
    s_waitcnt lgkmcnt(10)
    v_mfma_f32_16x16x32_bf16 v[176:179], v[160:163], v[104:107], v[176:179]
    v_and_b32 v250, 3, v1
    v_lshlrev_b32 v250, 2, v250
    v_add_u32 v250, 163776, v250
    s_mov_b32 s59, 2097152
L_lw_7:
    ds_read_b32 v251, v250 offset:16
    s_waitcnt lgkmcnt(0)
    v_cmp_gt_u32 vcc, 4, v251
    s_cbranch_vccz L_lw_7_ok
    s_sleep 1
    s_sub_u32 s59, s59, 1
    s_cmp_lg_u32 s59, 0
    s_cbranch_scc1 L_lw_7
L_lw_7_ok:
    v_xor_b32 v4, 0x10000, v4
    v_xor_b32 v7, 0x10000, v7
    v_xor_b32 v8, 0x10000, v8
    v_xor_b32 v9, 0x10000, v9
    v_xor_b32 v244, 0x10000, v244
    v_xor_b32 v245, 0x10000, v245
    ds_read_b64_tr_b16 v[144:145], v4 offset:0
    v_mfma_f32_16x16x32_bf16 v[180:183], v[160:163], v[108:111], v[180:183]
    ds_read_b64_tr_b16 v[146:147], v4 offset:512
    s_waitcnt lgkmcnt(10)
    v_mfma_f32_16x16x32_bf16 v[184:187], v[164:167], v[104:107], v[184:187]
    ds_read_b64_tr_b16 v[148:149], v7 offset:0
    v_mfma_f32_16x16x32_bf16 v[188:191], v[164:167], v[108:111], v[188:191]
    ds_read_b64_tr_b16 v[150:151], v7 offset:512
    s_waitcnt lgkmcnt(10)
    v_mfma_f32_16x16x32_bf16 v[192:195], v[168:171], v[104:107], v[192:195]
    ds_read_b64_tr_b16 v[152:153], v8 offset:0
    v_mfma_f32_16x16x32_bf16 v[196:199], v[168:171], v[108:111], v[196:199]
    ds_read_b64_tr_b16 v[154:155], v8 offset:512
    s_waitcnt lgkmcnt(10)
    v_mfma_f32_16x16x32_bf16 v[200:203], v[172:175], v[104:107], v[200:203]
    ds_read_b64_tr_b16 v[156:157], v9 offset:0
    v_mfma_f32_16x16x32_bf16 v[204:207], v[172:175], v[108:111], v[204:207]
    ds_read_b64_tr_b16 v[158:159], v9 offset:512
    s_waitcnt lgkmcnt(10)
    v_mfma_f32_16x16x32_bf16 v[208:211], v[232:235], v[104:107], v[208:211]
    ds_read_b64_tr_b16 v[224:225], v244 offset:24576
    v_mfma_f32_16x16x32_bf16 v[212:215], v[232:235], v[108:111], v[212:215]
    ds_read_b64_tr_b16 v[226:227], v244 offset:24832
    s_waitcnt lgkmcnt(10)
    v_mfma_f32_16x16x32_bf16 v[216:219], v[236:239], v[104:107], v[216:219]
    ds_read_b64_tr_b16 v[228:229], v245 offset:24576
    v_mfma_f32_16x16x32_bf16 v[220:223], v[236:239], v[108:111], v[220:223]
    ds_read_b64_tr_b16 v[230:231], v245 offset:24832
    s_waitcnt lgkmcnt(10)
    v_mfma_f32_16x16x32_bf16 v[176:179], v[144:147], v[112:115], v[176:179]
    ds_read_b64_tr_b16 v[160:161], v4 offset:4096
    v_mfma_f32_16x16x32_bf16 v[180:183], v[144:147], v[116:119], v[180:183]
    ds_read_b64_tr_b16 v[162:163], v4 offset:4608
    s_waitcnt lgkmcnt(10)
    v_mfma_f32_16x16x32_bf16 v[184:187], v[148:151], v[112:115], v[184:187]
    ds_read_b64_tr_b16 v[164:165], v7 offset:4096
    v_mfma_f32_16x16x32_bf16 v[188:191], v[148:151], v[116:119], v[188:191]
    ds_read_b64_tr_b16 v[166:167], v7 offset:4608
    s_waitcnt lgkmcnt(10)
    v_mfma_f32_16x16x32_bf16 v[192:195], v[152:155], v[112:115], v[192:195]
    ds_read_b64_tr_b16 v[168:169], v8 offset:4096
    v_mfma_f32_16x16x32_bf16 v[196:199], v[152:155], v[116:119], v[196:199]
    ds_read_b64_tr_b16 v[170:171], v8 offset:4608
    s_waitcnt lgkmcnt(10)
    v_mfma_f32_16x16x32_bf16 v[200:203], v[156:159], v[112:115], v[200:203]
    ds_read_b64_tr_b16 v[172:173], v9 offset:4096
    v_mfma_f32_16x16x32_bf16 v[204:207], v[156:159], v[116:119], v[204:207]
    ds_read_b64_tr_b16 v[174:175], v9 offset:4608
    s_waitcnt lgkmcnt(10)
    v_mfma_f32_16x16x32_bf16 v[208:211], v[224:227], v[112:115], v[208:211]
    ds_read_b64_tr_b16 v[232:233], v244 offset:26624
    v_mfma_f32_16x16x32_bf16 v[212:215], v[224:227], v[116:119], v[212:215]
    ds_read_b64_tr_b16 v[234:235], v244 offset:26880
    s_waitcnt lgkmcnt(10)
    v_mfma_f32_16x16x32_bf16 v[216:219], v[228:231], v[112:115], v[216:219]
    ds_read_b64_tr_b16 v[236:237], v245 offset:26624
    v_mfma_f32_16x16x32_bf16 v[220:223], v[228:231], v[116:119], v[220:223]
    ds_read_b64_tr_b16 v[238:239], v245 offset:26880
    s_waitcnt lgkmcnt(10)
    v_mfma_f32_16x16x32_bf16 v[176:179], v[160:163], v[120:123], v[176:179]
    ds_read_b64_tr_b16 v[144:145], v4 offset:8192
    v_mfma_f32_16x16x32_bf16 v[180:183], v[160:163], v[124:127], v[180:183]
    ds_read_b64_tr_b16 v[146:147], v4 offset:8704
    s_waitcnt lgkmcnt(10)
    v_mfma_f32_16x16x32_bf16 v[184:187], v[164:167], v[120:123], v[184:187]
    ds_read_b64_tr_b16 v[148:149], v7 offset:8192
    v_mfma_f32_16x16x32_bf16 v[188:191], v[164:167], v[124:127], v[188:191]
    ds_read_b64_tr_b16 v[150:151], v7 offset:8704
    s_waitcnt lgkmcnt(10)
    v_mfma_f32_16x16x32_bf16 v[192:195], v[168:171], v[120:123], v[192:195]
    ds_read_b64_tr_b16 v[152:153], v8 offset:8192
    v_mfma_f32_16x16x32_bf16 v[196:199], v[168:171], v[124:127], v[196:199]
    ds_read_b64_tr_b16 v[154:155], v8 offset:8704
    s_waitcnt lgkmcnt(10)
    v_mfma_f32_16x16x32_bf16 v[200:203], v[172:175], v[120:123], v[200:203]
    ds_read_b64_tr_b16 v[156:157], v9 offset:8192
    v_mfma_f32_16x16x32_bf16 v[204:207], v[172:175], v[124:127], v[204:207]
    ds_read_b64_tr_b16 v[158:159], v9 offset:8704
    s_waitcnt lgkmcnt(10)
    v_mfma_f32_16x16x32_bf16 v[208:211], v[232:235], v[120:123], v[208:211]
    ds_read_b64_tr_b16 v[224:225], v244 offset:57344
    v_mfma_f32_16x16x32_bf16 v[212:215], v[232:235], v[124:127], v[212:215]
    ds_read_b64_tr_b16 v[226:227], v244 offset:57600
    s_waitcnt lgkmcnt(10)
    v_mfma_f32_16x16x32_bf16 v[216:219], v[236:239], v[120:123], v[216:219]
    ds_read_b64_tr_b16 v[228:229], v245 offset:57344
    v_mfma_f32_16x16x32_bf16 v[220:223], v[236:239], v[124:127], v[220:223]
    ds_read_b64_tr_b16 v[230:231], v245 offset:57600
    s_waitcnt lgkmcnt(10)
    v_mfma_f32_16x16x32_bf16 v[176:179], v[144:147], v[128:131], v[176:179]
    ds_read_b64_tr_b16 v[160:161], v4 offset:12288
    v_mfma_f32_16x16x32_bf16 v[180:183], v[144:147], v[132:135], v[180:183]
    ds_read_b64_tr_b16 v[162:163], v4 offset:12800
    s_waitcnt lgkmcnt(10)
    v_mfma_f32_16x16x32_bf16 v[184:187], v[148:151], v[128:131], v[184:187]
    ds_read_b64_tr_b16 v[164:165], v7 offset:12288
    v_mfma_f32_16x16x32_bf16 v[188:191], v[148:151], v[132:135], v[188:191]
    ds_read_b64_tr_b16 v[166:167], v7 offset:12800
    s_waitcnt lgkmcnt(10)
    v_mfma_f32_16x16x32_bf16 v[192:195], v[152:155], v[128:131], v[192:195]
    ds_read_b64_tr_b16 v[168:169], v8 offset:12288
    v_mfma_f32_16x16x32_bf16 v[196:199], v[152:155], v[132:135], v[196:199]
    ds_read_b64_tr_b16 v[170:171], v8 offset:12800
    s_waitcnt lgkmcnt(10)
    v_mfma_f32_16x16x32_bf16 v[200:203], v[156:159], v[128:131], v[200:203]
    ds_read_b64_tr_b16 v[172:173], v9 offset:12288
    v_mfma_f32_16x16x32_bf16 v[204:207], v[156:159], v[132:135], v[204:207]
    ds_read_b64_tr_b16 v[174:175], v9 offset:12800
    s_waitcnt lgkmcnt(10)
    v_mfma_f32_16x16x32_bf16 v[208:211], v[224:227], v[128:131], v[208:211]
    ds_read_b64_tr_b16 v[232:233], v244 offset:59392
    v_mfma_f32_16x16x32_bf16 v[212:215], v[224:227], v[132:135], v[212:215]
    ds_read_b64_tr_b16 v[234:235], v244 offset:59648
    s_waitcnt lgkmcnt(10)
    v_mfma_f32_16x16x32_bf16 v[216:219], v[228:231], v[128:131], v[216:219]
    ds_read_b64_tr_b16 v[236:237], v245 offset:59392
    v_mfma_f32_16x16x32_bf16 v[220:223], v[228:231], v[132:135], v[220:223]
    ds_read_b64_tr_b16 v[238:239], v245 offset:59648
    s_waitcnt lgkmcnt(10)
    v_mfma_f32_16x16x32_bf16 v[176:179], v[160:163], v[136:139], v[176:179]
    v_mfma_f32_16x16x32_bf16 v[180:183], v[160:163], v[140:143], v[180:183]
    s_waitcnt lgkmcnt(8)
    v_mfma_f32_16x16x32_bf16 v[184:187], v[164:167], v[136:139], v[184:187]
    v_mfma_f32_16x16x32_bf16 v[188:191], v[164:167], v[140:143], v[188:191]
    s_waitcnt lgkmcnt(6)
    v_mfma_f32_16x16x32_bf16 v[192:195], v[168:171], v[136:139], v[192:195]
    v_mfma_f32_16x16x32_bf16 v[196:199], v[168:171], v[140:143], v[196:199]
    s_waitcnt lgkmcnt(4)
    v_mfma_f32_16x16x32_bf16 v[200:203], v[172:175], v[136:139], v[200:203]
    v_mfma_f32_16x16x32_bf16 v[204:207], v[172:175], v[140:143], v[204:207]
    s_waitcnt lgkmcnt(2)
    v_mfma_f32_16x16x32_bf16 v[208:211], v[232:235], v[136:139], v[208:211]
    v_mfma_f32_16x16x32_bf16 v[212:215], v[232:235], v[140:143], v[212:215]
    s_waitcnt lgkmcnt(0)
    v_mfma_f32_16x16x32_bf16 v[216:219], v[236:239], v[136:139], v[216:219]
    v_mfma_f32_16x16x32_bf16 v[220:223], v[236:239], v[140:143], v[220:223]
    s_nop 3
    v_cvt_pk_bf16_f32 v144, v176, v177
    v_cvt_pk_bf16_f32 v145, v178, v179
    v_cvt_pk_bf16_f32 v146, v180, v181
    v_cvt_pk_bf16_f32 v147, v182, v183
    v_cvt_pk_bf16_f32 v148, v184, v185
    v_cvt_pk_bf16_f32 v149, v186, v187
    v_cvt_pk_bf16_f32 v150, v188, v189
    v_cvt_pk_bf16_f32 v151, v190, v191
    v_permlane16_swap_b32 v144, v146
    v_permlane16_swap_b32 v145, v147
    s_add_u32 s59, s70, 8388608
    buffer_store_dwordx4 v[144:147], v2, s[16:19], s59 offen sc1
    v_cvt_pk_bf16_f32 v152, v192, v193
    v_cvt_pk_bf16_f32 v153, v194, v195
    v_cvt_pk_bf16_f32 v154, v196, v197
    v_cvt_pk_bf16_f32 v155, v198, v199
    v_permlane16_swap_b32 v148, v150
    v_permlane16_swap_b32 v149, v151
    s_add_u32 s59, s70, 8519680
    buffer_store_dwordx4 v[148:151], v2, s[16:19], s59 offen sc1
    v_cvt_pk_bf16_f32 v156, v200, v201
    v_cvt_pk_bf16_f32 v157, v202, v203
    v_cvt_pk_bf16_f32 v158, v204, v205
    v_cvt_pk_bf16_f32 v159, v206, v207
    v_permlane16_swap_b32 v152, v154
    v_permlane16_swap_b32 v153, v155
    s_add_u32 s59, s70, 8650752
    buffer_store_dwordx4 v[152:155], v2, s[16:19], s59 offen sc1
    s_nop 1
    v_permlane16_swap_b32 v156, v158
    v_permlane16_swap_b32 v157, v159
    s_add_u32 s59, s70, 8781824
    buffer_store_dwordx4 v[156:159], v2, s[16:19], s59 offen sc1
    s_branch L_p1_end
L_p1_v:
    s_barrier
    ds_read_b128 v[16:19], v5 offset:0
    ds_read_b128 v[20:23], v5 offset:2048
    ds_read_b64_tr_b16 v[144:145], v4 offset:16384
    ds_read_b64_tr_b16 v[146:147], v4 offset:16896
    ds_read_b64_tr_b16 v[148:149], v7 offset:16384
    ds_read_b64_tr_b16 v[150:151], v7 offset:16896
    ds_read_b64_tr_b16 v[152:153], v8 offset:16384
    ds_read_b64_tr_b16 v[154:155], v8 offset:16896
    ds_read_b64_tr_b16 v[156:157], v9 offset:16384
    ds_read_b64_tr_b16 v[158:159], v9 offset:16896
    ds_read_b64_tr_b16 v[224:225], v244 offset:24576
    ds_read_b64_tr_b16 v[226:227], v244 offset:24832
    ds_read_b64_tr_b16 v[228:229], v245 offset:24576
    ds_read_b64_tr_b16 v[230:231], v245 offset:24832
    s_waitcnt lgkmcnt(10)
    v_mfma_f32_16x16x32_bf16 v[176:179], v[16:19], v[144:147], 0
    ds_read_b128 v[24:27], v6 offset:0
    ds_read_b128 v[28:31], v6 offset:2048
    v_mfma_f32_16x16x32_bf16 v[180:183], v[20:23], v[144:147], 0
    ds_read_b64_tr_b16 v[160:161], v4 offset:20480
    ds_read_b64_tr_b16 v[162:163], v4 offset:20992
    s_waitcnt lgkmcnt(12)
    v_mfma_f32_16x16x32_bf16 v[184:187], v[16:19], v[148:151], 0
    ds_read_b64_tr_b16 v[164:165], v7 offset:20480
    v_mfma_f32_16x16x32_bf16 v[188:191], v[20:23], v[148:151], 0
    ds_read_b64_tr_b16 v[166:167], v7 offset:20992
    s_waitcnt lgkmcnt(12)
    v_mfma_f32_16x16x32_bf16 v[192:195], v[16:19], v[152:155], 0
    ds_read_b64_tr_b16 v[168:169], v8 offset:20480
    v_mfma_f32_16x16x32_bf16 v[196:199], v[20:23], v[152:155], 0
    ds_read_b64_tr_b16 v[170:171], v8 offset:20992
    s_waitcnt lgkmcnt(12)
    v_mfma_f32_16x16x32_bf16 v[200:203], v[16:19], v[156:159], 0
    ds_read_b64_tr_b16 v[172:173], v9 offset:20480
    v_mfma_f32_16x16x32_bf16 v[204:207], v[20:23], v[156:159], 0
    ds_read_b64_tr_b16 v[174:175], v9 offset:20992
    s_waitcnt lgkmcnt(12)
    v_mfma_f32_16x16x32_bf16 v[208:211], v[224:227], v[16:19], 0
    ds_read_b64_tr_b16 v[232:233], v244 offset:26624
    v_mfma_f32_16x16x32_bf16 v[212:215], v[224:227], v[20:23], 0
    ds_read_b64_tr_b16 v[234:235], v244 offset:26880
    s_waitcnt lgkmcnt(12)
    v_mfma_f32_16x16x32_bf16 v[216:219], v[228:231], v[16:19], 0
    ds_read_b64_tr_b16 v[236:237], v245 offset:26624
    v_mfma_f32_16x16x32_bf16 v[220:223], v[228:231], v[20:23], 0
    ds_read_b64_tr_b16 v[238:239], v245 offset:26880
    s_waitcnt lgkmcnt(10)
    v_mfma_f32_16x16x32_bf16 v[176:179], v[24:27], v[160:163], v[176:179]
    s_barrier
    ds_read_b128 v[32:35], v5 offset:32768
    ds_read_b128 v[36:39], v5 offset:34816
    v_mfma_f32_16x16x32_bf16 v[180:183], v[28:31], v[160:163], v[180:183]
    ds_read_b64_tr_b16 v[144:145], v4 offset:49152
    ds_read_b64_tr_b16 v[146:147], v4 offset:49664
    s_waitcnt lgkmcnt(12)
    v_mfma_f32_16x16x32_bf16 v[184:187], v[24:27], v[164:167], v[184:187]
    ds_read_b64_tr_b16 v[148:149], v7 offset:49152
    v_mfma_f32_16x16x32_bf16 v[188:191], v[28:31], v[164:167], v[188:191]
    ds_read_b64_tr_b16 v[150:151], v7 offset:49664
    s_waitcnt lgkmcnt(12)
    v_mfma_f32_16x16x32_bf16 v[192:195], v[24:27], v[168:171], v[192:195]
    ds_read_b64_tr_b16 v[152:153], v8 offset:49152
    v_mfma_f32_16x16x32_bf16 v[196:199], v[28:31], v[168:171], v[196:199]
    ds_read_b64_tr_b16 v[154:155], v8 offset:49664
    s_waitcnt lgkmcnt(12)
    v_mfma_f32_16x16x32_bf16 v[200:203], v[24:27], v[172:175], v[200:203]
    ds_read_b64_tr_b16 v[156:157], v9 offset:49152
    v_mfma_f32_16x16x32_bf16 v[204:207], v[28:31], v[172:175], v[204:207]
    ds_read_b64_tr_b16 v[158:159], v9 offset:49664
    s_waitcnt lgkmcnt(12)
    v_mfma_f32_16x16x32_bf16 v[208:211], v[232:235], v[24:27], v[208:211]
    ds_read_b64_tr_b16 v[224:225], v244 offset:57344
    v_mfma_f32_16x16x32_bf16 v[212:215], v[232:235], v[28:31], v[212:215]
    ds_read_b64_tr_b16 v[226:227], v244 offset:57600
    s_waitcnt lgkmcnt(12)
    v_mfma_f32_16x16x32_bf16 v[216:219], v[236:239], v[24:27], v[216:219]
    ds_read_b64_tr_b16 v[228:229], v245 offset:57344
    v_mfma_f32_16x16x32_bf16 v[220:223], v[236:239], v[28:31], v[220:223]
    ds_read_b64_tr_b16 v[230:231], v245 offset:57600
    s_waitcnt lgkmcnt(10)
    v_mfma_f32_16x16x32_bf16 v[176:179], v[32:35], v[144:147], v[176:179]
    ds_read_b128 v[40:43], v6 offset:32768
    ds_read_b128 v[44:47], v6 offset:34816
    v_mfma_f32_16x16x32_bf16 v[180:183], v[36:39], v[144:147], v[180:183]
    ds_read_b64_tr_b16 v[160:161], v4 offset:53248
    ds_read_b64_tr_b16 v[162:163], v4 offset:53760
    s_waitcnt lgkmcnt(12)
    v_mfma_f32_16x16x32_bf16 v[184:187], v[32:35], v[148:151], v[184:187]
    ds_read_b64_tr_b16 v[164:165], v7 offset:53248
    v_mfma_f32_16x16x32_bf16 v[188:191], v[36:39], v[148:151], v[188:191]
    ds_read_b64_tr_b16 v[166:167], v7 offset:53760
    s_waitcnt lgkmcnt(12)
    v_mfma_f32_16x16x32_bf16 v[192:195], v[32:35], v[152:155], v[192:195]
    ds_read_b64_tr_b16 v[168:169], v8 offset:53248
    v_mfma_f32_16x16x32_bf16 v[196:199], v[36:39], v[152:155], v[196:199]
    ds_read_b64_tr_b16 v[170:171], v8 offset:53760
    s_waitcnt lgkmcnt(12)
    v_mfma_f32_16x16x32_bf16 v[200:203], v[32:35], v[156:159], v[200:203]
    ds_read_b64_tr_b16 v[172:173], v9 offset:53248
    v_mfma_f32_16x16x32_bf16 v[204:207], v[36:39], v[156:159], v[204:207]
    ds_read_b64_tr_b16 v[174:175], v9 offset:53760
    s_waitcnt lgkmcnt(12)
    v_mfma_f32_16x16x32_bf16 v[208:211], v[224:227], v[32:35], v[208:211]
    ds_read_b64_tr_b16 v[232:233], v244 offset:59392
    v_mfma_f32_16x16x32_bf16 v[212:215], v[224:227], v[36:39], v[212:215]
    ds_read_b64_tr_b16 v[234:235], v244 offset:59648
    s_waitcnt lgkmcnt(12)
    v_mfma_f32_16x16x32_bf16 v[216:219], v[228:231], v[32:35], v[216:219]
    ds_read_b64_tr_b16 v[236:237], v245 offset:59392
    v_mfma_f32_16x16x32_bf16 v[220:223], v[228:231], v[36:39], v[220:223]
    ds_read_b64_tr_b16 v[238:239], v245 offset:59648
    s_waitcnt lgkmcnt(10)
    v_mfma_f32_16x16x32_bf16 v[176:179], v[40:43], v[160:163], v[176:179]
    s_barrier
    v_xor_b32 v5, 0x10000, v5
    v_xor_b32 v6, 0x10000, v6
    v_xor_b32 v4, 0x10000, v4
    v_xor_b32 v7, 0x10000, v7
    v_xor_b32 v8, 0x10000, v8
    v_xor_b32 v9, 0x10000, v9
    v_xor_b32 v244, 0x10000, v244
    v_xor_b32 v245, 0x10000, v245
    ds_read_b128 v[48:51], v5 offset:0
    ds_read_b128 v[52:55], v5 offset:2048
    v_mfma_f32_16x16x32_bf16 v[180:183], v[44:47], v[160:163], v[180:183]
    ds_read_b64_tr_b16 v[144:145], v4 offset:16384
    ds_read_b64_tr_b16 v[146:147], v4 offset:16896
    s_waitcnt lgkmcnt(12)
    v_mfma_f32_16x16x32_bf16 v[184:187], v[40:43], v[164:167], v[184:187]
    ds_read_b64_tr_b16 v[148:149], v7 offset:16384
    v_mfma_f32_16x16x32_bf16 v[188:191], v[44:47], v[164:167], v[188:191]
    ds_read_b64_tr_b16 v[150:151], v7 offset:16896
    s_waitcnt lgkmcnt(12)
    v_mfma_f32_16x16x32_bf16 v[192:195], v[40:43], v[168:171], v[192:195]
    ds_read_b64_tr_b16 v[152:153], v8 offset:16384
    v_mfma_f32_16x16x32_bf16 v[196:199], v[44:47], v[168:171], v[196:199]
    ds_read_b64_tr_b16 v[154:155], v8 offset:16896
    s_waitcnt lgkmcnt(12)
    v_mfma_f32_16x16x32_bf16 v[200:203], v[40:43], v[172:175], v[200:203]
    ds_read_b64_tr_b16 v[156:157], v9 offset:16384
    v_mfma_f32_16x16x32_bf16 v[204:207], v[44:47], v[172:175], v[204:207]
    ds_read_b64_tr_b16 v[158:159], v9 offset:16896
    s_waitcnt lgkmcnt(12)
    v_mfma_f32_16x16x32_bf16 v[208:211], v[232:235], v[40:43], v[208:211]
    ds_read_b64_tr_b16 v[224:225], v244 offset:24576
    v_mfma_f32_16x16x32_bf16 v[212:215], v[232:235], v[44:47], v[212:215]
    ds_read_b64_tr_b16 v[226:227], v244 offset:24832
    s_waitcnt lgkmcnt(12)
    v_mfma_f32_16x16x32_bf16 v[216:219], v[236:239], v[40:43], v[216:219]
    ds_read_b64_tr_b16 v[228:229], v245 offset:24576
    v_mfma_f32_16x16x32_bf16 v[220:223], v[236:239], v[44:47], v[220:223]
    ds_read_b64_tr_b16 v[230:231], v245 offset:24832
    s_waitcnt lgkmcnt(10)
    v_mfma_f32_16x16x32_bf16 v[176:179], v[48:51], v[144:147], v[176:179]
    ds_read_b128 v[56:59], v6 offset:0
    ds_read_b128 v[60:63], v6 offset:2048
    v_mfma_f32_16x16x32_bf16 v[180:183], v[52:55], v[144:147], v[180:183]
    ds_read_b64_tr_b16 v[160:161], v4 offset:20480
    ds_read_b64_tr_b16 v[162:163], v4 offset:20992
    s_waitcnt lgkmcnt(12)
    v_mfma_f32_16x16x32_bf16 v[184:187], v[48:51], v[148:151], v[184:187]
    ds_read_b64_tr_b16 v[164:165], v7 offset:20480
    v_mfma_f32_16x16x32_bf16 v[188:191], v[52:55], v[148:151], v[188:191]
    ds_read_b64_tr_b16 v[166:167], v7 offset:20992
    s_waitcnt lgkmcnt(12)
    v_mfma_f32_16x16x32_bf16 v[192:195], v[48:51], v[152:155], v[192:195]
    ds_read_b64_tr_b16 v[168:169], v8 offset:20480
    v_mfma_f32_16x16x32_bf16 v[196:199], v[52:55], v[152:155], v[196:199]
    ds_read_b64_tr_b16 v[170:171], v8 offset:20992
    s_waitcnt lgkmcnt(12)
    v_mfma_f32_16x16x32_bf16 v[200:203], v[48:51], v[156:159], v[200:203]
    ds_read_b64_tr_b16 v[172:173], v9 offset:20480
    v_mfma_f32_16x16x32_bf16 v[204:207], v[52:55], v[156:159], v[204:207]
    ds_read_b64_tr_b16 v[174:175], v9 offset:20992
    s_waitcnt lgkmcnt(12)
    v_mfma_f32_16x16x32_bf16 v[208:211], v[224:227], v[48:51], v[208:211]
    ds_read_b64_tr_b16 v[232:233], v244 offset:26624
    v_mfma_f32_16x16x32_bf16 v[212:215], v[224:227], v[52:55], v[212:215]
    ds_read_b64_tr_b16 v[234:235], v244 offset:26880
    s_waitcnt lgkmcnt(12)
    v_mfma_f32_16x16x32_bf16 v[216:219], v[228:231], v[48:51], v[216:219]
    ds_read_b64_tr_b16 v[236:237], v245 offset:26624
    v_mfma_f32_16x16x32_bf16 v[220:223], v[228:231], v[52:55], v[220:223]
    ds_read_b64_tr_b16 v[238:239], v245 offset:26880
    s_waitcnt lgkmcnt(10)
    v_mfma_f32_16x16x32_bf16 v[176:179], v[56:59], v[160:163], v[176:179]
    s_barrier
    ds_read_b128 v[64:67], v5 offset:32768
    ds_read_b128 v[68:71], v5 offset:34816
    v_mfma_f32_16x16x32_bf16 v[180:183], v[60:63], v[160:163], v[180:183]
    ds_read_b64_tr_b16 v[144:145], v4 offset:49152
    ds_read_b64_tr_b16 v[146:147], v4 offset:49664
    s_waitcnt lgkmcnt(12)
    v_mfma_f32_16x16x32_bf16 v[184:187], v[56:59], v[164:167], v[184:187]
    ds_read_b64_tr_b16 v[148:149], v7 offset:49152
    v_mfma_f32_16x16x32_bf16 v[188:191], v[60:63], v[164:167], v[188:191]
    ds_read_b64_tr_b16 v[150:151], v7 offset:49664
    s_waitcnt lgkmcnt(12)
    v_mfma_f32_16x16x32_bf16 v[192:195], v[56:59], v[168:171], v[192:195]
    ds_read_b64_tr_b16 v[152:153], v8 offset:49152
    v_mfma_f32_16x16x32_bf16 v[196:199], v[60:63], v[168:171], v[196:199]
    ds_read_b64_tr_b16 v[154:155], v8 offset:49664
    s_waitcnt lgkmcnt(12)
    v_mfma_f32_16x16x32_bf16 v[200:203], v[56:59], v[172:175], v[200:203]
    ds_read_b64_tr_b16 v[156:157], v9 offset:49152
    v_mfma_f32_16x16x32_bf16 v[204:207], v[60:63], v[172:175], v[204:207]
    ds_read_b64_tr_b16 v[158:159], v9 offset:49664
    s_waitcnt lgkmcnt(12)
    v_mfma_f32_16x16x32_bf16 v[208:211], v[232:235], v[56:59], v[208:211]
    ds_read_b64_tr_b16 v[224:225], v244 offset:57344
    v_mfma_f32_16x16x32_bf16 v[212:215], v[232:235], v[60:63], v[212:215]
    ds_read_b64_tr_b16 v[226:227], v244 offset:57600
    s_waitcnt lgkmcnt(12)
    v_mfma_f32_16x16x32_bf16 v[216:219], v[236:239], v[56:59], v[216:219]
    ds_read_b64_tr_b16 v[228:229], v245 offset:57344
    v_mfma_f32_16x16x32_bf16 v[220:223], v[236:239], v[60:63], v[220:223]
    ds_read_b64_tr_b16 v[230:231], v245 offset:57600
    s_waitcnt lgkmcnt(10)
    v_mfma_f32_16x16x32_bf16 v[176:179], v[64:67], v[144:147], v[176:179]
    ds_read_b128 v[72:75], v6 offset:32768
    ds_read_b128 v[76:79], v6 offset:34816
    v_mfma_f32_16x16x32_bf16 v[180:183], v[68:71], v[144:147], v[180:183]
    ds_read_b64_tr_b16 v[160:161], v4 offset:53248
    ds_read_b64_tr_b16 v[162:163], v4 offset:53760
    s_waitcnt lgkmcnt(12)
    v_mfma_f32_16x16x32_bf16 v[184:187], v[64:67], v[148:151], v[184:187]
    ds_read_b64_tr_b16 v[164:165], v7 offset:53248
    v_mfma_f32_16x16x32_bf16 v[188:191], v[68:71], v[148:151], v[188:191]
    ds_read_b64_tr_b16 v[166:167], v7 offset:53760
    s_waitcnt lgkmcnt(12)
    v_mfma_f32_16x16x32_bf16 v[192:195], v[64:67], v[152:155], v[192:195]
    ds_read_b64_tr_b16 v[168:169], v8 offset:53248
    v_mfma_f32_16x16x32_bf16 v[196:199], v[68:71], v[152:155], v[196:199]
    ds_read_b64_tr_b16 v[170:171], v8 offset:53760
    s_waitcnt lgkmcnt(12)
    v_mfma_f32_16x16x32_bf16 v[200:203], v[64:67], v[156:159], v[200:203]
    ds_read_b64_tr_b16 v[172:173], v9 offset:53248
    v_mfma_f32_16x16x32_bf16 v[204:207], v[68:71], v[156:159], v[204:207]
    ds_read_b64_tr_b16 v[174:175], v9 offset:53760
    s_waitcnt lgkmcnt(12)
    v_mfma_f32_16x16x32_bf16 v[208:211], v[224:227], v[64:67], v[208:211]
    ds_read_b64_tr_b16 v[232:233], v244 offset:59392
    v_mfma_f32_16x16x32_bf16 v[212:215], v[224:227], v[68:71], v[212:215]
    ds_read_b64_tr_b16 v[234:235], v244 offset:59648
    s_waitcnt lgkmcnt(12)
    v_mfma_f32_16x16x32_bf16 v[216:219], v[228:231], v[64:67], v[216:219]
    ds_read_b64_tr_b16 v[236:237], v245 offset:59392
    v_mfma_f32_16x16x32_bf16 v[220:223], v[228:231], v[68:71], v[220:223]
    ds_read_b64_tr_b16 v[238:239], v245 offset:59648
    s_waitcnt lgkmcnt(10)
    v_mfma_f32_16x16x32_bf16 v[176:179], v[72:75], v[160:163], v[176:179]
    s_barrier
    v_xor_b32 v5, 0x10000, v5
    v_xor_b32 v6, 0x10000, v6
    v_xor_b32 v4, 0x10000, v4
    v_xor_b32 v7, 0x10000, v7
    v_xor_b32 v8, 0x10000, v8
    v_xor_b32 v9, 0x10000, v9
    v_xor_b32 v244, 0x10000, v244
    v_xor_b32 v245, 0x10000, v245
    ds_read_b128 v[80:83], v5 offset:0
    ds_read_b128 v[84:87], v5 offset:2048
    v_mfma_f32_16x16x32_bf16 v[180:183], v[76:79], v[160:163], v[180:183]
    ds_read_b64_tr_b16 v[144:145], v4 offset:16384
    ds_read_b64_tr_b16 v[146:147], v4 offset:16896
    s_waitcnt lgkmcnt(12)
    v_mfma_f32_16x16x32_bf16 v[184:187], v[72:75], v[164:167], v[184:187]
    ds_read_b64_tr_b16 v[148:149], v7 offset:16384
    v_mfma_f32_16x16x32_bf16 v[188:191], v[76:79], v[164:167], v[188:191]
    ds_read_b64_tr_b16 v[150:151], v7 offset:16896
    s_waitcnt lgkmcnt(12)
    v_mfma_f32_16x16x32_bf16 v[192:195], v[72:75], v[168:171], v[192:195]
    ds_read_b64_tr_b16 v[152:153], v8 offset:16384
    v_mfma_f32_16x16x32_bf16 v[196:199], v[76:79], v[168:171], v[196:199]
    ds_read_b64_tr_b16 v[154:155], v8 offset:16896
    s_waitcnt lgkmcnt(12)
    v_mfma_f32_16x16x32_bf16 v[200:203], v[72:75], v[172:175], v[200:203]
    ds_read_b64_tr_b16 v[156:157], v9 offset:16384
    v_mfma_f32_16x16x32_bf16 v[204:207], v[76:79], v[172:175], v[204:207]
    ds_read_b64_tr_b16 v[158:159], v9 offset:16896
    s_waitcnt lgkmcnt(12)
    v_mfma_f32_16x16x32_bf16 v[208:211], v[232:235], v[72:75], v[208:211]
    ds_read_b64_tr_b16 v[224:225], v244 offset:24576
    v_mfma_f32_16x16x32_bf16 v[212:215], v[232:235], v[76:79], v[212:215]
    ds_read_b64_tr_b16 v[226:227], v244 offset:24832
    s_waitcnt lgkmcnt(12)
    v_mfma_f32_16x16x32_bf16 v[216:219], v[236:239], v[72:75], v[216:219]
    ds_read_b64_tr_b16 v[228:229], v245 offset:24576
    v_mfma_f32_16x16x32_bf16 v[220:223], v[236:239], v[76:79], v[220:223]
    ds_read_b64_tr_b16 v[230:231], v245 offset:24832
    s_waitcnt vmcnt(0)
    v_mov_b32 v249, 0
    buffer_load_dwordx2 v[254:255], v249, s[20:23], 0 offen sc1
    s_waitcnt lgkmcnt(10)
    v_mfma_f32_16x16x32_bf16 v[176:179], v[80:83], v[144:147], v[176:179]
    ds_read_b128 v[88:91], v6 offset:0
    ds_read_b128 v[92:95], v6 offset:2048
    v_mfma_f32_16x16x32_bf16 v[180:183], v[84:87], v[144:147], v[180:183]
    ds_read_b64_tr_b16 v[160:161], v4 offset:20480
    ds_read_b64_tr_b16 v[162:163], v4 offset:20992
    s_waitcnt lgkmcnt(12)
    v_mfma_f32_16x16x32_bf16 v[184:187], v[80:83], v[148:151], v[184:187]
    ds_read_b64_tr_b16 v[164:165], v7 offset:20480
    v_mfma_f32_16x16x32_bf16 v[188:191], v[84:87], v[148:151], v[188:191]
    ds_read_b64_tr_b16 v[166:167], v7 offset:20992
    s_waitcnt lgkmcnt(12)
    v_mfma_f32_16x16x32_bf16 v[192:195], v[80:83], v[152:155], v[192:195]
    ds_read_b64_tr_b16 v[168:169], v8 offset:20480
    v_mfma_f32_16x16x32_bf16 v[196:199], v[84:87], v[152:155], v[196:199]
    ds_read_b64_tr_b16 v[170:171], v8 offset:20992
    s_waitcnt lgkmcnt(12)
    v_mfma_f32_16x16x32_bf16 v[200:203], v[80:83], v[156:159], v[200:203]
    ds_read_b64_tr_b16 v[172:173], v9 offset:20480
    v_mfma_f32_16x16x32_bf16 v[204:207], v[84:87], v[156:159], v[204:207]
    ds_read_b64_tr_b16 v[174:175], v9 offset:20992
    s_waitcnt lgkmcnt(12)
    v_mfma_f32_16x16x32_bf16 v[208:211], v[224:227], v[80:83], v[208:211]
    ds_read_b64_tr_b16 v[232:233], v244 offset:26624
    v_mfma_f32_16x16x32_bf16 v[212:215], v[224:227], v[84:87], v[212:215]
    ds_read_b64_tr_b16 v[234:235], v244 offset:26880
    s_waitcnt lgkmcnt(12)
    v_mfma_f32_16x16x32_bf16 v[216:219], v[228:231], v[80:83], v[216:219]
    ds_read_b64_tr_b16 v[236:237], v245 offset:26624
    v_mfma_f32_16x16x32_bf16 v[220:223], v[228:231], v[84:87], v[220:223]
    ds_read_b64_tr_b16 v[238:239], v245 offset:26880
    s_waitcnt lgkmcnt(10)
    v_mfma_f32_16x16x32_bf16 v[176:179], v[88:91], v[160:163], v[176:179]
    s_barrier
    ds_read_b128 v[96:99], v5 offset:32768
    ds_read_b128 v[100:103], v5 offset:34816
    v_mfma_f32_16x16x32_bf16 v[180:183], v[92:95], v[160:163], v[180:183]
    ds_read_b64_tr_b16 v[144:145], v4 offset:49152
    ds_read_b64_tr_b16 v[146:147], v4 offset:49664
    s_waitcnt lgkmcnt(12)
    v_mfma_f32_16x16x32_bf16 v[184:187], v[88:91], v[164:167], v[184:187]
    ds_read_b64_tr_b16 v[148:149], v7 offset:49152
    v_mfma_f32_16x16x32_bf16 v[188:191], v[92:95], v[164:167], v[188:191]
    ds_read_b64_tr_b16 v[150:151], v7 offset:49664
    s_waitcnt lgkmcnt(12)
    v_mfma_f32_16x16x32_bf16 v[192:195], v[88:91], v[168:171], v[192:195]
    ds_read_b64_tr_b16 v[152:153], v8 offset:49152
    v_mfma_f32_16x16x32_bf16 v[196:199], v[92:95], v[168:171], v[196:199]
    ds_read_b64_tr_b16 v[154:155], v8 offset:49664
    s_waitcnt lgkmcnt(12)
    v_mfma_f32_16x16x32_bf16 v[200:203], v[88:91], v[172:175], v[200:203]
    ds_read_b64_tr_b16 v[156:157], v9 offset:49152
    v_mfma_f32_16x16x32_bf16 v[204:207], v[92:95], v[172:175], v[204:207]
    ds_read_b64_tr_b16 v[158:159], v9 offset:49664
    s_waitcnt lgkmcnt(12)
    v_mfma_f32_16x16x32_bf16 v[208:211], v[232:235], v[88:91], v[208:211]
    ds_read_b64_tr_b16 v[224:225], v244 offset:57344
    v_mfma_f32_16x16x32_bf16 v[212:215], v[232:235], v[92:95], v[212:215]
    ds_read_b64_tr_b16 v[226:227], v244 offset:57600
    s_waitcnt lgkmcnt(12)
    v_mfma_f32_16x16x32_bf16 v[216:219], v[236:239], v[88:91], v[216:219]
    ds_read_b64_tr_b16 v[228:229], v245 offset:57344
    v_mfma_f32_16x16x32_bf16 v[220:223], v[236:239], v[92:95], v[220:223]
    ds_read_b64_tr_b16 v[230:231], v245 offset:57600
    s_waitcnt lgkmcnt(10)
    v_mfma_f32_16x16x32_bf16 v[176:179], v[96:99], v[144:147], v[176:179]
    ds_read_b128 v[104:107], v6 offset:32768
    ds_read_b128 v[108:111], v6 offset:34816
    v_mfma_f32_16x16x32_bf16 v[180:183], v[100:103], v[144:147], v[180:183]
    ds_read_b64_tr_b16 v[160:161], v4 offset:53248
    ds_read_b64_tr_b16 v[162:163], v4 offset:53760
    s_waitcnt lgkmcnt(12)
    v_mfma_f32_16x16x32_bf16 v[184:187], v[96:99], v[148:151], v[184:187]
    ds_read_b64_tr_b16 v[164:165], v7 offset:53248
    v_mfma_f32_16x16x32_bf16 v[188:191], v[100:103], v[148:151], v[188:191]
    ds_read_b64_tr_b16 v[166:167], v7 offset:53760
    s_waitcnt lgkmcnt(12)
    v_mfma_f32_16x16x32_bf16 v[192:195], v[96:99], v[152:155], v[192:195]
    ds_read_b64_tr_b16 v[168:169], v8 offset:53248
    v_mfma_f32_16x16x32_bf16 v[196:199], v[100:103], v[152:155], v[196:199]
    ds_read_b64_tr_b16 v[170:171], v8 offset:53760
    s_waitcnt lgkmcnt(12)
    v_mfma_f32_16x16x32_bf16 v[200:203], v[96:99], v[156:159], v[200:203]
    ds_read_b64_tr_b16 v[172:173], v9 offset:53248
    v_mfma_f32_16x16x32_bf16 v[204:207], v[100:103], v[156:159], v[204:207]
    ds_read_b64_tr_b16 v[174:175], v9 offset:53760
    s_waitcnt lgkmcnt(12)
    v_mfma_f32_16x16x32_bf16 v[208:211], v[224:227], v[96:99], v[208:211]
    ds_read_b64_tr_b16 v[232:233], v244 offset:59392
    v_mfma_f32_16x16x32_bf16 v[212:215], v[224:227], v[100:103], v[212:215]
    ds_read_b64_tr_b16 v[234:235], v244 offset:59648
    s_waitcnt lgkmcnt(12)
    v_mfma_f32_16x16x32_bf16 v[216:219], v[228:231], v[96:99], v[216:219]
    ds_read_b64_tr_b16 v[236:237], v245 offset:59392
    v_mfma_f32_16x16x32_bf16 v[220:223], v[228:231], v[100:103], v[220:223]
    ds_read_b64_tr_b16 v[238:239], v245 offset:59648
    s_waitcnt lgkmcnt(10)
    v_mfma_f32_16x16x32_bf16 v[176:179], v[104:107], v[160:163], v[176:179]
    s_barrier
    v_xor_b32 v5, 0x10000, v5
    v_xor_b32 v6, 0x10000, v6
    v_xor_b32 v4, 0x10000, v4
    v_xor_b32 v7, 0x10000, v7
    v_xor_b32 v8, 0x10000, v8
    v_xor_b32 v9, 0x10000, v9
    v_xor_b32 v244, 0x10000, v244
    v_xor_b32 v245, 0x10000, v245
    ds_read_b128 v[112:115], v5 offset:0
    ds_read_b128 v[116:119], v5 offset:2048
    v_mfma_f32_16x16x32_bf16 v[180:183], v[108:111], v[160:163], v[180:183]
    ds_read_b64_tr_b16 v[144:145], v4 offset:16384
    ds_read_b64_tr_b16 v[146:147], v4 offset:16896
    s_waitcnt lgkmcnt(12)
    v_mfma_f32_16x16x32_bf16 v[184:187], v[104:107], v[164:167], v[184:187]
    ds_read_b64_tr_b16 v[148:149], v7 offset:16384
    v_mfma_f32_16x16x32_bf16 v[188:191], v[108:111], v[164:167], v[188:191]
    ds_read_b64_tr_b16 v[150:151], v7 offset:16896
    s_waitcnt lgkmcnt(12)
    v_mfma_f32_16x16x32_bf16 v[192:195], v[104:107], v[168:171], v[192:195]
    ds_read_b64_tr_b16 v[152:153], v8 offset:16384
    v_mfma_f32_16x16x32_bf16 v[196:199], v[108:111], v[168:171], v[196:199]
    ds_read_b64_tr_b16 v[154:155], v8 offset:16896
    s_waitcnt lgkmcnt(12)
    v_mfma_f32_16x16x32_bf16 v[200:203], v[104:107], v[172:175], v[200:203]
    ds_read_b64_tr_b16 v[156:157], v9 offset:16384
    v_mfma_f32_16x16x32_bf16 v[204:207], v[108:111], v[172:175], v[204:207]
    ds_read_b64_tr_b16 v[158:159], v9 offset:16896
    s_waitcnt lgkmcnt(12)
    v_mfma_f32_16x16x32_bf16 v[208:211], v[232:235], v[104:107], v[208:211]
    ds_read_b64_tr_b16 v[224:225], v244 offset:24576
    v_mfma_f32_16x16x32_bf16 v[212:215], v[232:235], v[108:111], v[212:215]
    ds_read_b64_tr_b16 v[226:227], v244 offset:24832
    s_waitcnt lgkmcnt(12)
    v_mfma_f32_16x16x32_bf16 v[216:219], v[236:239], v[104:107], v[216:219]
    ds_read_b64_tr_b16 v[228:229], v245 offset:24576
    v_mfma_f32_16x16x32_bf16 v[220:223], v[236:239], v[108:111], v[220:223]
    ds_read_b64_tr_b16 v[230:231], v245 offset:24832
    s_waitcnt lgkmcnt(10)
    v_mfma_f32_16x16x32_bf16 v[176:179], v[112:115], v[144:147], v[176:179]
    ds_read_b128 v[120:123], v6 offset:0
    ds_read_b128 v[124:127], v6 offset:2048
    v_mfma_f32_16x16x32_bf16 v[180:183], v[116:119], v[144:147], v[180:183]
    ds_read_b64_tr_b16 v[160:161], v4 offset:20480
    ds_read_b64_tr_b16 v[162:163], v4 offset:20992
    s_waitcnt lgkmcnt(12)
    v_mfma_f32_16x16x32_bf16 v[184:187], v[112:115], v[148:151], v[184:187]
    ds_read_b64_tr_b16 v[164:165], v7 offset:20480
    v_mfma_f32_16x16x32_bf16 v[188:191], v[116:119], v[148:151], v[188:191]
    ds_read_b64_tr_b16 v[166:167], v7 offset:20992
    s_waitcnt lgkmcnt(12)
    v_mfma_f32_16x16x32_bf16 v[192:195], v[112:115], v[152:155], v[192:195]
    ds_read_b64_tr_b16 v[168:169], v8 offset:20480
    v_mfma_f32_16x16x32_bf16 v[196:199], v[116:119], v[152:155], v[196:199]
    ds_read_b64_tr_b16 v[170:171], v8 offset:20992
    s_waitcnt lgkmcnt(12)
    v_mfma_f32_16x16x32_bf16 v[200:203], v[112:115], v[156:159], v[200:203]
    ds_read_b64_tr_b16 v[172:173], v9 offset:20480
    v_mfma_f32_16x16x32_bf16 v[204:207], v[116:119], v[156:159], v[204:207]
    ds_read_b64_tr_b16 v[174:175], v9 offset:20992
    s_waitcnt lgkmcnt(12)
    v_mfma_f32_16x16x32_bf16 v[208:211], v[224:227], v[112:115], v[208:211]
    ds_read_b64_tr_b16 v[232:233], v244 offset:26624
    v_mfma_f32_16x16x32_bf16 v[212:215], v[224:227], v[116:119], v[212:215]
    ds_read_b64_tr_b16 v[234:235], v244 offset:26880
    s_waitcnt lgkmcnt(12)
    v_mfma_f32_16x16x32_bf16 v[216:219], v[228:231], v[112:115], v[216:219]
    ds_read_b64_tr_b16 v[236:237], v245 offset:26624
    v_mfma_f32_16x16x32_bf16 v[220:223], v[228:231], v[116:119], v[220:223]
    ds_read_b64_tr_b16 v[238:239], v245 offset:26880
    s_waitcnt lgkmcnt(10)
    v_mfma_f32_16x16x32_bf16 v[176:179], v[120:123], v[160:163], v[176:179]
    s_barrier
    ds_read_b128 v[128:131], v5 offset:32768
    ds_read_b128 v[132:135], v5 offset:34816
    v_mfma_f32_16x16x32_bf16 v[180:183], v[124:127], v[160:163], v[180:183]
    ds_read_b64_tr_b16 v[144:145], v4 offset:49152
    ds_read_b64_tr_b16 v[146:147], v4 offset:49664
    s_waitcnt lgkmcnt(12)
    v_mfma_f32_16x16x32_bf16 v[184:187], v[120:123], v[164:167], v[184:187]
    ds_read_b64_tr_b16 v[148:149], v7 offset:49152
    v_mfma_f32_16x16x32_bf16 v[188:191], v[124:127], v[164:167], v[188:191]
    ds_read_b64_tr_b16 v[150:151], v7 offset:49664
    s_waitcnt lgkmcnt(12)
    v_mfma_f32_16x16x32_bf16 v[192:195], v[120:123], v[168:171], v[192:195]
    ds_read_b64_tr_b16 v[152:153], v8 offset:49152
    v_mfma_f32_16x16x32_bf16 v[196:199], v[124:127], v[168:171], v[196:199]
    ds_read_b64_tr_b16 v[154:155], v8 offset:49664
    s_waitcnt lgkmcnt(12)
    v_mfma_f32_16x16x32_bf16 v[200:203], v[120:123], v[172:175], v[200:203]
    ds_read_b64_tr_b16 v[156:157], v9 offset:49152
    v_mfma_f32_16x16x32_bf16 v[204:207], v[124:127], v[172:175], v[204:207]
    ds_read_b64_tr_b16 v[158:159], v9 offset:49664
    s_waitcnt lgkmcnt(12)
    v_mfma_f32_16x16x32_bf16 v[208:211], v[232:235], v[120:123], v[208:211]
    ds_read_b64_tr_b16 v[224:225], v244 offset:57344
    v_mfma_f32_16x16x32_bf16 v[212:215], v[232:235], v[124:127], v[212:215]
    ds_read_b64_tr_b16 v[226:227], v244 offset:57600
    s_waitcnt lgkmcnt(12)
    v_mfma_f32_16x16x32_bf16 v[216:219], v[236:239], v[120:123], v[216:219]
    ds_read_b64_tr_b16 v[228:229], v245 offset:57344
    v_mfma_f32_16x16x32_bf16 v[220:223], v[236:239], v[124:127], v[220:223]
    ds_read_b64_tr_b16 v[230:231], v245 offset:57600
    s_waitcnt lgkmcnt(10)
    v_mfma_f32_16x16x32_bf16 v[176:179], v[128:131], v[144:147], v[176:179]
    ds_read_b128 v[136:139], v6 offset:32768
    ds_read_b128 v[140:143], v6 offset:34816
    v_mfma_f32_16x16x32_bf16 v[180:183], v[132:135], v[144:147], v[180:183]
    ds_read_b64_tr_b16 v[160:161], v4 offset:53248
    ds_read_b64_tr_b16 v[162:163], v4 offset:53760
    s_waitcnt lgkmcnt(12)
    v_mfma_f32_16x16x32_bf16 v[184:187], v[128:131], v[148:151], v[184:187]
    ds_read_b64_tr_b16 v[164:165], v7 offset:53248
    v_mfma_f32_16x16x32_bf16 v[188:191], v[132:135], v[148:151], v[188:191]
    ds_read_b64_tr_b16 v[166:167], v7 offset:53760
    s_waitcnt lgkmcnt(12)
    v_mfma_f32_16x16x32_bf16 v[192:195], v[128:131], v[152:155], v[192:195]
    ds_read_b64_tr_b16 v[168:169], v8 offset:53248
    v_mfma_f32_16x16x32_bf16 v[196:199], v[132:135], v[152:155], v[196:199]
    ds_read_b64_tr_b16 v[170:171], v8 offset:53760
    s_waitcnt lgkmcnt(12)
    v_mfma_f32_16x16x32_bf16 v[200:203], v[128:131], v[156:159], v[200:203]
    ds_read_b64_tr_b16 v[172:173], v9 offset:53248
    v_mfma_f32_16x16x32_bf16 v[204:207], v[132:135], v[156:159], v[204:207]
    ds_read_b64_tr_b16 v[174:175], v9 offset:53760
    s_waitcnt lgkmcnt(12)
    v_mfma_f32_16x16x32_bf16 v[208:211], v[224:227], v[128:131], v[208:211]
    ds_read_b64_tr_b16 v[232:233], v244 offset:59392
    v_mfma_f32_16x16x32_bf16 v[212:215], v[224:227], v[132:135], v[212:215]
    ds_read_b64_tr_b16 v[234:235], v244 offset:59648
    s_waitcnt lgkmcnt(12)
    v_mfma_f32_16x16x32_bf16 v[216:219], v[228:231], v[128:131], v[216:219]
    ds_read_b64_tr_b16 v[236:237], v245 offset:59392
    v_mfma_f32_16x16x32_bf16 v[220:223], v[228:231], v[132:135], v[220:223]
    ds_read_b64_tr_b16 v[238:239], v245 offset:59648
    s_waitcnt lgkmcnt(10)
    v_mfma_f32_16x16x32_bf16 v[176:179], v[136:139], v[160:163], v[176:179]
    v_mfma_f32_16x16x32_bf16 v[180:183], v[140:143], v[160:163], v[180:183]
    s_waitcnt lgkmcnt(8)
    v_mfma_f32_16x16x32_bf16 v[184:187], v[136:139], v[164:167], v[184:187]
    v_mfma_f32_16x16x32_bf16 v[188:191], v[140:143], v[164:167], v[188:191]
    s_waitcnt lgkmcnt(6)
    v_mfma_f32_16x16x32_bf16 v[192:195], v[136:139], v[168:171], v[192:195]
    v_mfma_f32_16x16x32_bf16 v[196:199], v[140:143], v[168:171], v[196:199]
    s_waitcnt lgkmcnt(4)
    v_mfma_f32_16x16x32_bf16 v[200:203], v[136:139], v[172:175], v[200:203]
    v_mfma_f32_16x16x32_bf16 v[204:207], v[140:143], v[172:175], v[204:207]
    s_waitcnt lgkmcnt(2)
    v_mfma_f32_16x16x32_bf16 v[208:211], v[232:235], v[136:139], v[208:211]
    v_mfma_f32_16x16x32_bf16 v[212:215], v[232:235], v[140:143], v[212:215]
    s_waitcnt lgkmcnt(0)
    v_mfma_f32_16x16x32_bf16 v[216:219], v[236:239], v[136:139], v[216:219]
    v_mfma_f32_16x16x32_bf16 v[220:223], v[236:239], v[140:143], v[220:223]
    s_nop 3
    v_cvt_pk_bf16_f32 v144, v176, v177
    v_cvt_pk_bf16_f32 v145, v178, v179
    v_cvt_pk_bf16_f32 v146, v184, v185
    v_cvt_pk_bf16_f32 v147, v186, v187
    v_cvt_pk_bf16_f32 v148, v180, v181
    v_cvt_pk_bf16_f32 v149, v182, v183
    v_cvt_pk_bf16_f32 v150, v188, v189
    v_cvt_pk_bf16_f32 v151, v190, v191
    v_permlane16_swap_b32 v144, v146
    v_permlane16_swap_b32 v145, v147
    s_add_u32 s59, s70, 4194304
    buffer_store_dwordx4 v[144:147], v3, s[16:19], s59 offen offset:1024 sc1
    v_cvt_pk_bf16_f32 v152, v192, v193
    v_cvt_pk_bf16_f32 v153, v194, v195
    v_cvt_pk_bf16_f32 v154, v200, v201
    v_cvt_pk_bf16_f32 v155, v202, v203
    v_permlane16_swap_b32 v148, v150
    v_permlane16_swap_b32 v149, v151
    s_add_u32 s59, s70, 4194304
    buffer_store_dwordx4 v[148:151], v3, s[16:19], s59 offen offset:1536 sc1
    v_cvt_pk_bf16_f32 v156, v196, v197
    v_cvt_pk_bf16_f32 v157, v198, v199
    v_cvt_pk_bf16_f32 v158, v204, v205
    v_cvt_pk_bf16_f32 v159, v206, v207
    v_permlane16_swap_b32 v152, v154
    v_permlane16_swap_b32 v153, v155
    s_add_u32 s59, s70, 4456448
    buffer_store_dwordx4 v[152:155], v3, s[16:19], s59 offen offset:1024 sc1
    s_nop 1
    v_permlane16_swap_b32 v156, v158
    v_permlane16_swap_b32 v157, v159
    s_add_u32 s59, s70, 4456448
    buffer_store_dwordx4 v[156:159], v3, s[16:19], s59 offen offset:1536 sc1
    v_mov_b32 v250, 163776
    v_mov_b32 v251, 1
    s_mov_b64 exec, 1
    ds_add_u32 v250, v251 offset:4
    s_mov_b64 exec, -1
    s_setprio 3
    v_mul_f32 v208, s69, v208
    v_mul_f32 v209, s69, v209
    v_mul_f32 v210, s69, v210
    v_mul_f32 v211, s69, v211
    v_mul_f32 v212, s69, v212
    v_mul_f32 v213, s69, v213
    v_mul_f32 v214, s69, v214
    v_mul_f32 v215, s69, v215
    v_mul_f32 v216, s69, v216
    v_mul_f32 v217, s69, v217
    v_mul_f32 v218, s69, v218
    v_mul_f32 v219, s69, v219
    v_mul_f32 v220, s69, v220
    v_mul_f32 v221, s69, v221
    v_mul_f32 v222, s69, v222
    v_mul_f32 v223, s69, v223
    v_cvt_pk_bf16_f32 v208, v208, v209
    v_cvt_pk_bf16_f32 v209, v210, v211
    v_cvt_pk_bf16_f32 v210, v212, v213
    v_cvt_pk_bf16_f32 v211, v214, v215
    v_cvt_pk_bf16_f32 v212, v216, v217
    v_cvt_pk_bf16_f32 v213, v218, v219
    v_cvt_pk_bf16_f32 v214, v220, v221
    v_cvt_pk_bf16_f32 v215, v222, v223
    v_permlane16_swap_b32 v208, v210
    v_permlane16_swap_b32 v209, v211
    v_permlane16_swap_b32 v212, v214
    v_permlane16_swap_b32 v213, v215
    ds_write_b128 v248, v[208:211] offset:0
    ds_write_b128 v248, v[212:215] offset:4096
    s_waitcnt lgkmcnt(0)
    v_mov_b32 v250, 163776
    v_mov_b32 v251, 1
    s_mov_b64 exec, 1
    ds_add_u32 v250, v251 offset:56
    s_mov_b64 exec, -1
    ds_read_b128 v[176:179], v0 offset:0
    ds_read_b128 v[180:183], v0 offset:64
    ds_read_b128 v[184:187], v0 offset:128
    ds_read_b128 v[188:191], v0 offset:192
    ds_read_b128 v[192:195], v0 offset:256
    ds_read_b128 v[196:199], v0 offset:320
    ds_read_b128 v[200:203], v0 offset:384
    ds_read_b128 v[204:207], v0 offset:448
    s_waitcnt lgkmcnt(4)
    v_dot2c_f32_bf16 v14, v16, v176
    v_dot2c_f32_bf16 v15, v20, v176
    v_dot2c_f32_bf16 v10, v17, v177
    v_dot2c_f32_bf16 v11, v21, v177
    v_dot2c_f32_bf16 v14, v18, v178
    v_dot2c_f32_bf16 v15, v22, v178
    v_dot2c_f32_bf16 v10, v19, v179
    v_dot2c_f32_bf16 v11, v23, v179
    v_dot2c_f32_bf16 v14, v24, v180
    v_dot2c_f32_bf16 v15, v28, v180
    v_dot2c_f32_bf16 v10, v25, v181
    v_dot2c_f32_bf16 v11, v29, v181
    v_dot2c_f32_bf16 v14, v26, v182
    v_dot2c_f32_bf16 v15, v30, v182
    v_dot2c_f32_bf16 v10, v27, v183
    v_dot2c_f32_bf16 v11, v31, v183
    v_dot2c_f32_bf16 v14, v32, v184
    v_dot2c_f32_bf16 v15, v36, v184
    v_dot2c_f32_bf16 v10, v33, v185
    v_dot2c_f32_bf16 v11, v37, v185
    v_dot2c_f32_bf16 v14, v34, v186
    v_dot2c_f32_bf16 v15, v38, v186
    v_dot2c_f32_bf16 v10, v35, v187
    v_dot2c_f32_bf16 v11, v39, v187
    v_dot2c_f32_bf16 v14, v40, v188
    v_dot2c_f32_bf16 v15, v44, v188
    v_dot2c_f32_bf16 v10, v41, v189
    v_dot2c_f32_bf16 v11, v45, v189
    v_dot2c_f32_bf16 v14, v42, v190
    v_dot2c_f32_bf16 v15, v46, v190
    v_dot2c_f32_bf16 v10, v43, v191
    v_dot2c_f32_bf16 v11, v47, v191
    ds_read_b128 v[176:179], v0 offset:512
    ds_read_b128 v[180:183], v0 offset:576
    ds_read_b128 v[184:187], v0 offset:640
    ds_read_b128 v[188:191], v0 offset:704
    s_waitcnt lgkmcnt(4)
    v_dot2c_f32_bf16 v14, v48, v192
    v_dot2c_f32_bf16 v15, v52, v192
    v_dot2c_f32_bf16 v10, v49, v193
    v_dot2c_f32_bf16 v11, v53, v193
    v_dot2c_f32_bf16 v14, v50, v194
    v_dot2c_f32_bf16 v15, v54, v194
    v_dot2c_f32_bf16 v10, v51, v195
    v_dot2c_f32_bf16 v11, v55, v195
    v_dot2c_f32_bf16 v14, v56, v196
    v_dot2c_f32_bf16 v15, v60, v196
    v_dot2c_f32_bf16 v10, v57, v197
    v_dot2c_f32_bf16 v11, v61, v197
    v_dot2c_f32_bf16 v14, v58, v198
    v_dot2c_f32_bf16 v15, v62, v198
    v_dot2c_f32_bf16 v10, v59, v199
    v_dot2c_f32_bf16 v11, v63, v199
    v_dot2c_f32_bf16 v14, v64, v200
    v_dot2c_f32_bf16 v15, v68, v200
    v_dot2c_f32_bf16 v10, v65, v201
    v_dot2c_f32_bf16 v11, v69, v201
    v_dot2c_f32_bf16 v14, v66, v202
    v_dot2c_f32_bf16 v15, v70, v202
    v_dot2c_f32_bf16 v10, v67, v203
    v_dot2c_f32_bf16 v11, v71, v203
    v_dot2c_f32_bf16 v14, v72, v204
    v_dot2c_f32_bf16 v15, v76, v204
    v_dot2c_f32_bf16 v10, v73, v205
    v_dot2c_f32_bf16 v11, v77, v205
    v_dot2c_f32_bf16 v14, v74, v206
    v_dot2c_f32_bf16 v15, v78, v206
    v_dot2c_f32_bf16 v10, v75, v207
    v_dot2c_f32_bf16 v11, v79, v207
    ds_read_b128 v[192:195], v0 offset:768
    ds_read_b128 v[196:199], v0 offset:832
    ds_read_b128 v[200:203], v0 offset:896
    ds_read_b128 v[204:207], v0 offset:960
    s_waitcnt lgkmcnt(4)
    v_dot2c_f32_bf16 v14, v80, v176
    v_dot2c_f32_bf16 v15, v84, v176
    v_dot2c_f32_bf16 v10, v81, v177
    v_dot2c_f32_bf16 v11, v85, v177
    v_dot2c_f32_bf16 v14, v82, v178
    v_dot2c_f32_bf16 v15, v86, v178
    v_dot2c_f32_bf16 v10, v83, v179
    v_dot2c_f32_bf16 v11, v87, v179
    v_dot2c_f32_bf16 v14, v88, v180
    v_dot2c_f32_bf16 v15, v92, v180
    v_dot2c_f32_bf16 v10, v89, v181
    v_dot2c_f32_bf16 v11, v93, v181
    v_dot2c_f32_bf16 v14, v90, v182
    v_dot2c_f32_bf16 v15, v94, v182
    v_dot2c_f32_bf16 v10, v91, v183
    v_dot2c_f32_bf16 v11, v95, v183
    v_dot2c_f32_bf16 v14, v96, v184
    v_dot2c_f32_bf16 v15, v100, v184
    v_dot2c_f32_bf16 v10, v97, v185
    v_dot2c_f32_bf16 v11, v101, v185
    v_dot2c_f32_bf16 v14, v98, v186
    v_dot2c_f32_bf16 v15, v102, v186
    v_dot2c_f32_bf16 v10, v99, v187
    v_dot2c_f32_bf16 v11, v103, v187
    v_dot2c_f32_bf16 v14, v104, v188
    v_dot2c_f32_bf16 v15, v108, v188
    v_dot2c_f32_bf16 v10, v105, v189
    v_dot2c_f32_bf16 v11, v109, v189
    v_dot2c_f32_bf16 v14, v106, v190
    v_dot2c_f32_bf16 v15, v110, v190
    v_dot2c_f32_bf16 v10, v107, v191
    v_dot2c_f32_bf16 v11, v111, v191
    s_waitcnt lgkmcnt(0)
    v_dot2c_f32_bf16 v14, v112, v192
    v_dot2c_f32_bf16 v15, v116, v192
    v_dot2c_f32_bf16 v10, v113, v193
    v_dot2c_f32_bf16 v11, v117, v193
    v_dot2c_f32_bf16 v14, v114, v194
    v_dot2c_f32_bf16 v15, v118, v194
    v_dot2c_f32_bf16 v10, v115, v195
    v_dot2c_f32_bf16 v11, v119, v195
    v_dot2c_f32_bf16 v14, v120, v196
    v_dot2c_f32_bf16 v15, v124, v196
    v_dot2c_f32_bf16 v10, v121, v197
    v_dot2c_f32_bf16 v11, v125, v197
    v_dot2c_f32_bf16 v14, v122, v198
    v_dot2c_f32_bf16 v15, v126, v198
    v_dot2c_f32_bf16 v10, v123, v199
    v_dot2c_f32_bf16 v11, v127, v199
    v_dot2c_f32_bf16 v14, v128, v200
    v_dot2c_f32_bf16 v15, v132, v200
    v_dot2c_f32_bf16 v10, v129, v201
    v_dot2c_f32_bf16 v11, v133, v201
    v_dot2c_f32_bf16 v14, v130, v202
    v_dot2c_f32_bf16 v15, v134, v202
    v_dot2c_f32_bf16 v10, v131, v203
    v_dot2c_f32_bf16 v11, v135, v203
    v_dot2c_f32_bf16 v14, v136, v204
    v_dot2c_f32_bf16 v15, v140, v204
    v_dot2c_f32_bf16 v10, v137, v205
    v_dot2c_f32_bf16 v11, v141, v205
    v_dot2c_f32_bf16 v14, v138, v206
    v_dot2c_f32_bf16 v15, v142, v206
    v_dot2c_f32_bf16 v10, v139, v207
    v_dot2c_f32_bf16 v11, v143, v207
    v_and_b32 v5, 31, v1
    s_lshl_b32 s59, s68, 7
    s_add_u32 s59, s59, 154624
    v_lshl_add_u32 v5, v5, 2, s59
    v_add_f32 v14, v14, v10
    v_add_f32 v15, v15, v11
    s_nop 1
    v_permlane16_swap_b32 v14, v15
    s_nop 1
    v_add_f32 v14, v14, v15
    v_mov_b32 v15, v14
    s_nop 1
    v_permlane32_swap_b32 v14, v15
    s_nop 1
    v_add_f32 v14, v14, v15
    v_mul_f32 v14, 0xbfb8aa3b, v14
    v_exp_f32 v14, v14
    s_nop 0
    v_add_f32 v14, 1.0, v14
    v_rcp_f32 v14, v14
    s_nop 0
    ds_write_b32 v5, v14
    s_waitcnt lgkmcnt(0)
    s_waitcnt vmcnt(0)
    s_mov_b32 s59, 262144
L_tag_8:
    v_cmp_eq_u32 vcc, 0, v255
    s_cbranch_vccz L_tag_8_ok
    buffer_load_dwordx2 v[254:255], v249, s[20:23], 0 offen sc1
    s_waitcnt vmcnt(0)
    s_sleep 1
    s_sub_u32 s59, s59, 1
    s_cmp_lg_u32 s59, 0
    s_cbranch_scc1 L_tag_8
L_tag_8_ok:
    v_readfirstlane_b32 s30, v254
    v_readfirstlane_b32 s31, v255
    v_mov_b32 v250, 163776
    v_mov_b32 v251, 1
    s_mov_b64 exec, 1
    ds_add_rtn_u32 v251, v250, v251 offset:0
    s_lshl_b32 s60, s55, 5
    s_add_u32 s60, s60, s3
    s_lshl_b32 s60, s60, 7
    s_add_u32 s60, s60, 17039360
    s_waitcnt lgkmcnt(0)
    v_readfirstlane_b32 s59, v251
    s_mov_b64 exec, 0xff
    v_mov_b32 v252, s30
    v_mov_b32 v253, s31
    v_mov_b32 v254, s30
    v_mov_b32 v255, s31
    s_cmp_lg_u32 s59, 3
    s_cbranch_scc1 L_pub_9
    buffer_store_dwordx4 v[252:255], v2, s[16:19], s60 offen sc1
L_pub_9:
    s_mov_b64 exec, -1
    v_and_b32 v250, 3, v1
    v_lshlrev_b32 v250, 2, v250
    v_add_u32 v250, 163776, v250
    s_mov_b32 s59, 2097152
L_lw_10:
    ds_read_b32 v251, v250 offset:16
    s_waitcnt lgkmcnt(0)
    v_cmp_gt_u32 vcc, 2, v251
    s_cbranch_vccz L_lw_10_ok
    s_sleep 1
    s_sub_u32 s59, s59, 1
    s_cmp_lg_u32 s59, 0
    s_cbranch_scc1 L_lw_10
L_lw_10_ok:
    v_xor_b32 v4, 0x10000, v4
    v_xor_b32 v7, 0x10000, v7
    v_xor_b32 v8, 0x10000, v8
    v_xor_b32 v9, 0x10000, v9
    v_xor_b32 v244, 0x10000, v244
    v_xor_b32 v245, 0x10000, v245
    ds_read_b64_tr_b16 v[144:145], v4 offset:0
    ds_read_b64_tr_b16 v[146:147], v4 offset:512
    ds_read_b64_tr_b16 v[148:149], v7 offset:0
    ds_read_b64_tr_b16 v[150:151], v7 offset:512
    ds_read_b64_tr_b16 v[152:153], v8 offset:0
    ds_read_b64_tr_b16 v[154:155], v8 offset:512
    ds_read_b64_tr_b16 v[156:157], v9 offset:0
    ds_read_b64_tr_b16 v[158:159], v9 offset:512
    ds_read_b64_tr_b16 v[224:225], v244 offset:28672
    ds_read_b64_tr_b16 v[226:227], v244 offset:28928
    ds_read_b64_tr_b16 v[228:229], v245 offset:28672
    ds_read_b64_tr_b16 v[230:231], v245 offset:28928
    s_waitcnt lgkmcnt(10)
    v_mfma_f32_16x16x32_bf16 v[176:179], v[16:19], v[144:147], 0
    ds_read_b64_tr_b16 v[160:161], v4 offset:4096
    v_mfma_f32_16x16x32_bf16 v[180:183], v[20:23], v[144:147], 0
    ds_read_b64_tr_b16 v[162:163], v4 offset:4608
    s_waitcnt lgkmcnt(10)
    v_mfma_f32_16x16x32_bf16 v[184:187], v[16:19], v[148:151], 0
    ds_read_b64_tr_b16 v[164:165], v7 offset:4096
    v_mfma_f32_16x16x32_bf16 v[188:191], v[20:23], v[148:151], 0
    ds_read_b64_tr_b16 v[166:167], v7 offset:4608
    s_waitcnt lgkmcnt(10)
    v_mfma_f32_16x16x32_bf16 v[192:195], v[16:19], v[152:155], 0
    ds_read_b64_tr_b16 v[168:169], v8 offset:4096
    v_mfma_f32_16x16x32_bf16 v[196:199], v[20:23], v[152:155], 0
    ds_read_b64_tr_b16 v[170:171], v8 offset:4608
    s_waitcnt lgkmcnt(10)
    v_mfma_f32_16x16x32_bf16 v[200:203], v[16:19], v[156:159], 0
    ds_read_b64_tr_b16 v[172:173], v9 offset:4096
    v_mfma_f32_16x16x32_bf16 v[204:207], v[20:23], v[156:159], 0
    ds_read_b64_tr_b16 v[174:175], v9 offset:4608
    s_waitcnt lgkmcnt(10)
    v_mfma_f32_16x16x32_bf16 v[208:211], v[224:227], v[16:19], 0
    ds_read_b64_tr_b16 v[232:233], v244 offset:30720
    v_mfma_f32_16x16x32_bf16 v[212:215], v[224:227], v[20:23], 0
    ds_read_b64_tr_b16 v[234:235], v244 offset:30976
    s_waitcnt lgkmcnt(10)
    v_mfma_f32_16x16x32_bf16 v[216:219], v[228:231], v[16:19], 0
    ds_read_b64_tr_b16 v[236:237], v245 offset:30720
    v_mfma_f32_16x16x32_bf16 v[220:223], v[228:231], v[20:23], 0
    ds_read_b64_tr_b16 v[238:239], v245 offset:30976
    s_waitcnt lgkmcnt(10)
    v_mfma_f32_16x16x32_bf16 v[176:179], v[24:27], v[160:163], v[176:179]
    ds_read_b64_tr_b16 v[144:145], v4 offset:8192
    v_mfma_f32_16x16x32_bf16 v[180:183], v[28:31], v[160:163], v[180:183]
    ds_read_b64_tr_b16 v[146:147], v4 offset:8704
    s_waitcnt lgkmcnt(10)
    v_mfma_f32_16x16x32_bf16 v[184:187], v[24:27], v[164:167], v[184:187]
    ds_read_b64_tr_b16 v[148:149], v7 offset:8192
    v_mfma_f32_16x16x32_bf16 v[188:191], v[28:31], v[164:167], v[188:191]
    ds_read_b64_tr_b16 v[150:151], v7 offset:8704
    s_waitcnt lgkmcnt(10)
    v_mfma_f32_16x16x32_bf16 v[192:195], v[24:27], v[168:171], v[192:195]
    ds_read_b64_tr_b16 v[152:153], v8 offset:8192
    v_mfma_f32_16x16x32_bf16 v[196:199], v[28:31], v[168:171], v[196:199]
    ds_read_b64_tr_b16 v[154:155], v8 offset:8704
    s_waitcnt lgkmcnt(10)
    v_mfma_f32_16x16x32_bf16 v[200:203], v[24:27], v[172:175], v[200:203]
    ds_read_b64_tr_b16 v[156:157], v9 offset:8192
    v_mfma_f32_16x16x32_bf16 v[204:207], v[28:31], v[172:175], v[204:207]
    ds_read_b64_tr_b16 v[158:159], v9 offset:8704
    s_waitcnt lgkmcnt(10)
    v_mfma_f32_16x16x32_bf16 v[208:211], v[232:235], v[24:27], v[208:211]
    ds_read_b64_tr_b16 v[224:225], v244 offset:61440
    v_mfma_f32_16x16x32_bf16 v[212:215], v[232:235], v[28:31], v[212:215]
    ds_read_b64_tr_b16 v[226:227], v244 offset:61696
    s_waitcnt lgkmcnt(10)
    v_mfma_f32_16x16x32_bf16 v[216:219], v[236:239], v[24:27], v[216:219]
    ds_read_b64_tr_b16 v[228:229], v245 offset:61440
    v_mfma_f32_16x16x32_bf16 v[220:223], v[236:239], v[28:31], v[220:223]
    ds_read_b64_tr_b16 v[230:231], v245 offset:61696
    s_waitcnt lgkmcnt(10)
    v_mfma_f32_16x16x32_bf16 v[176:179], v[32:35], v[144:147], v[176:179]
    ds_read_b64_tr_b16 v[160:161], v4 offset:12288
    v_mfma_f32_16x16x32_bf16 v[180:183], v[36:39], v[144:147], v[180:183]
    ds_read_b64_tr_b16 v[162:163], v4 offset:12800
    s_waitcnt lgkmcnt(10)
    v_mfma_f32_16x16x32_bf16 v[184:187], v[32:35], v[148:151], v[184:187]
    ds_read_b64_tr_b16 v[164:165], v7 offset:12288
    v_mfma_f32_16x16x32_bf16 v[188:191], v[36:39], v[148:151], v[188:191]
    ds_read_b64_tr_b16 v[166:167], v7 offset:12800
    s_waitcnt lgkmcnt(10)
    v_mfma_f32_16x16x32_bf16 v[192:195], v[32:35], v[152:155], v[192:195]
    ds_read_b64_tr_b16 v[168:169], v8 offset:12288
    v_mfma_f32_16x16x32_bf16 v[196:199], v[36:39], v[152:155], v[196:199]
    ds_read_b64_tr_b16 v[170:171], v8 offset:12800
    s_waitcnt lgkmcnt(10)
    v_mfma_f32_16x16x32_bf16 v[200:203], v[32:35], v[156:159], v[200:203]
    ds_read_b64_tr_b16 v[172:173], v9 offset:12288
    v_mfma_f32_16x16x32_bf16 v[204:207], v[36:39], v[156:159], v[204:207]
    ds_read_b64_tr_b16 v[174:175], v9 offset:12800
    s_waitcnt lgkmcnt(10)
    v_mfma_f32_16x16x32_bf16 v[208:211], v[224:227], v[32:35], v[208:211]
    ds_read_b64_tr_b16 v[232:233], v244 offset:63488
    v_mfma_f32_16x16x32_bf16 v[212:215], v[224:227], v[36:39], v[212:215]
    ds_read_b64_tr_b16 v[234:235], v244 offset:63744
    s_waitcnt lgkmcnt(10)
    v_mfma_f32_16x16x32_bf16 v[216:219], v[228:231], v[32:35], v[216:219]
    ds_read_b64_tr_b16 v[236:237], v245 offset:63488
    v_mfma_f32_16x16x32_bf16 v[220:223], v[228:231], v[36:39], v[220:223]
    ds_read_b64_tr_b16 v[238:239], v245 offset:63744
    s_waitcnt lgkmcnt(10)
    v_mfma_f32_16x16x32_bf16 v[176:179], v[40:43], v[160:163], v[176:179]
    v_xor_b32 v244, 0x10000, v244
    v_xor_b32 v245, 0x10000, v245
    ds_read_b64_tr_b16 v[144:145], v4 offset:16384
    v_mfma_f32_16x16x32_bf16 v[180:183], v[44:47], v[160:163], v[180:183]
    ds_read_b64_tr_b16 v[146:147], v4 offset:16896
    s_waitcnt lgkmcnt(10)
    v_mfma_f32_16x16x32_bf16 v[184:187], v[40:43], v[164:167], v[184:187]
    ds_read_b64_tr_b16 v[148:149], v7 offset:16384
    v_mfma_f32_16x16x32_bf16 v[188:191], v[44:47], v[164:167], v[188:191]
    ds_read_b64_tr_b16 v[150:151], v7 offset:16896
    s_waitcnt lgkmcnt(10)
    v_mfma_f32_16x16x32_bf16 v[192:195], v[40:43], v[168:171], v[192:195]
    ds_read_b64_tr_b16 v[152:153], v8 offset:16384
    v_mfma_f32_16x16x32_bf16 v[196:199], v[44:47], v[168:171], v[196:199]
    ds_read_b64_tr_b16 v[154:155], v8 offset:16896
    s_waitcnt lgkmcnt(10)
    v_mfma_f32_16x16x32_bf16 v[200:203], v[40:43], v[172:175], v[200:203]
    ds_read_b64_tr_b16 v[156:157], v9 offset:16384
    v_mfma_f32_16x16x32_bf16 v[204:207], v[44:47], v[172:175], v[204:207]
    ds_read_b64_tr_b16 v[158:159], v9 offset:16896
    s_waitcnt lgkmcnt(10)
    v_mfma_f32_16x16x32_bf16 v[208:211], v[232:235], v[40:43], v[208:211]
    ds_read_b64_tr_b16 v[224:225], v244 offset:28672
    v_mfma_f32_16x16x32_bf16 v[212:215], v[232:235], v[44:47], v[212:215]
    ds_read_b64_tr_b16 v[226:227], v244 offset:28928
    s_waitcnt lgkmcnt(10)
    v_mfma_f32_16x16x32_bf16 v[216:219], v[236:239], v[40:43], v[216:219]
    ds_read_b64_tr_b16 v[228:229], v245 offset:28672
    v_mfma_f32_16x16x32_bf16 v[220:223], v[236:239], v[44:47], v[220:223]
    ds_read_b64_tr_b16 v[230:231], v245 offset:28928
    s_waitcnt lgkmcnt(10)
    v_mfma_f32_16x16x32_bf16 v[176:179], v[48:51], v[144:147], v[176:179]
    ds_read_b64_tr_b16 v[160:161], v4 offset:20480
    v_mfma_f32_16x16x32_bf16 v[180:183], v[52:55], v[144:147], v[180:183]
    ds_read_b64_tr_b16 v[162:163], v4 offset:20992
    s_waitcnt lgkmcnt(10)
    v_mfma_f32_16x16x32_bf16 v[184:187], v[48:51], v[148:151], v[184:187]
    ds_read_b64_tr_b16 v[164:165], v7 offset:20480
    v_mfma_f32_16x16x32_bf16 v[188:191], v[52:55], v[148:151], v[188:191]
    ds_read_b64_tr_b16 v[166:167], v7 offset:20992
    s_waitcnt lgkmcnt(10)
    v_mfma_f32_16x16x32_bf16 v[192:195], v[48:51], v[152:155], v[192:195]
    ds_read_b64_tr_b16 v[168:169], v8 offset:20480
    v_mfma_f32_16x16x32_bf16 v[196:199], v[52:55], v[152:155], v[196:199]
    ds_read_b64_tr_b16 v[170:171], v8 offset:20992
    s_waitcnt lgkmcnt(10)
    v_mfma_f32_16x16x32_bf16 v[200:203], v[48:51], v[156:159], v[200:203]
    ds_read_b64_tr_b16 v[172:173], v9 offset:20480
    v_mfma_f32_16x16x32_bf16 v[204:207], v[52:55], v[156:159], v[204:207]
    ds_read_b64_tr_b16 v[174:175], v9 offset:20992
    s_waitcnt lgkmcnt(10)
    v_mfma_f32_16x16x32_bf16 v[208:211], v[224:227], v[48:51], v[208:211]
    ds_read_b64_tr_b16 v[232:233], v244 offset:30720
    v_mfma_f32_16x16x32_bf16 v[212:215], v[224:227], v[52:55], v[212:215]
    ds_read_b64_tr_b16 v[234:235], v244 offset:30976
    s_waitcnt lgkmcnt(10)
    v_mfma_f32_16x16x32_bf16 v[216:219], v[228:231], v[48:51], v[216:219]
    ds_read_b64_tr_b16 v[236:237], v245 offset:30720
    v_mfma_f32_16x16x32_bf16 v[220:223], v[228:231], v[52:55], v[220:223]
    ds_read_b64_tr_b16 v[238:239], v245 offset:30976
    s_waitcnt lgkmcnt(10)
    v_mfma_f32_16x16x32_bf16 v[176:179], v[56:59], v[160:163], v[176:179]
    v_and_b32 v250, 3, v1
    v_lshlrev_b32 v250, 2, v250
    v_add_u32 v250, 163776, v250
    s_mov_b32 s59, 2097152
L_lw_11:
    ds_read_b32 v251, v250 offset:16
    s_waitcnt lgkmcnt(0)
    v_cmp_gt_u32 vcc, 3, v251
    s_cbranch_vccz L_lw_11_ok
    s_sleep 1
    s_sub_u32 s59, s59, 1
    s_cmp_lg_u32 s59, 0
    s_cbranch_scc1 L_lw_11
L_lw_11_ok:
    ds_read_b64_tr_b16 v[144:145], v4 offset:32768
    v_mfma_f32_16x16x32_bf16 v[180:183], v[60:63], v[160:163], v[180:183]
    ds_read_b64_tr_b16 v[146:147], v4 offset:33280
    s_waitcnt lgkmcnt(10)
    v_mfma_f32_16x16x32_bf16 v[184:187], v[56:59], v[164:167], v[184:187]
    ds_read_b64_tr_b16 v[148:149], v7 offset:32768
    v_mfma_f32_16x16x32_bf16 v[188:191], v[60:63], v[164:167], v[188:191]
    ds_read_b64_tr_b16 v[150:151], v7 offset:33280
    s_waitcnt lgkmcnt(10)
    v_mfma_f32_16x16x32_bf16 v[192:195], v[56:59], v[168:171], v[192:195]
    ds_read_b64_tr_b16 v[152:153], v8 offset:32768
    v_mfma_f32_16x16x32_bf16 v[196:199], v[60:63], v[168:171], v[196:199]
    ds_read_b64_tr_b16 v[154:155], v8 offset:33280
    s_waitcnt lgkmcnt(10)
    v_mfma_f32_16x16x32_bf16 v[200:203], v[56:59], v[172:175], v[200:203]
    ds_read_b64_tr_b16 v[156:157], v9 offset:32768
    v_mfma_f32_16x16x32_bf16 v[204:207], v[60:63], v[172:175], v[204:207]
    ds_read_b64_tr_b16 v[158:159], v9 offset:33280
    s_waitcnt lgkmcnt(10)
    v_mfma_f32_16x16x32_bf16 v[208:211], v[232:235], v[56:59], v[208:211]
    ds_read_b64_tr_b16 v[224:225], v244 offset:61440
    v_mfma_f32_16x16x32_bf16 v[212:215], v[232:235], v[60:63], v[212:215]
    ds_read_b64_tr_b16 v[226:227], v244 offset:61696
    s_waitcnt lgkmcnt(10)
    v_mfma_f32_16x16x32_bf16 v[216:219], v[236:239], v[56:59], v[216:219]
    ds_read_b64_tr_b16 v[228:229], v245 offset:61440
    v_mfma_f32_16x16x32_bf16 v[220:223], v[236:239], v[60:63], v[220:223]
    ds_read_b64_tr_b16 v[230:231], v245 offset:61696
    s_waitcnt lgkmcnt(10)
    v_mfma_f32_16x16x32_bf16 v[176:179], v[64:67], v[144:147], v[176:179]
    ds_read_b64_tr_b16 v[160:161], v4 offset:36864
    v_mfma_f32_16x16x32_bf16 v[180:183], v[68:71], v[144:147], v[180:183]
    ds_read_b64_tr_b16 v[162:163], v4 offset:37376
    s_waitcnt lgkmcnt(10)
    v_mfma_f32_16x16x32_bf16 v[184:187], v[64:67], v[148:151], v[184:187]
    ds_read_b64_tr_b16 v[164:165], v7 offset:36864
    v_mfma_f32_16x16x32_bf16 v[188:191], v[68:71], v[148:151], v[188:191]
    ds_read_b64_tr_b16 v[166:167], v7 offset:37376
    s_waitcnt lgkmcnt(10)
    v_mfma_f32_16x16x32_bf16 v[192:195], v[64:67], v[152:155], v[192:195]
    ds_read_b64_tr_b16 v[168:169], v8 offset:36864
    v_mfma_f32_16x16x32_bf16 v[196:199], v[68:71], v[152:155], v[196:199]
    ds_read_b64_tr_b16 v[170:171], v8 offset:37376
    s_waitcnt lgkmcnt(10)
    v_mfma_f32_16x16x32_bf16 v[200:203], v[64:67], v[156:159], v[200:203]
    ds_read_b64_tr_b16 v[172:173], v9 offset:36864
    v_mfma_f32_16x16x32_bf16 v[204:207], v[68:71], v[156:159], v[204:207]
    ds_read_b64_tr_b16 v[174:175], v9 offset:37376
    s_waitcnt lgkmcnt(10)
    v_mfma_f32_16x16x32_bf16 v[208:211], v[224:227], v[64:67], v[208:211]
    ds_read_b64_tr_b16 v[232:233], v244 offset:63488
    v_mfma_f32_16x16x32_bf16 v[212:215], v[224:227], v[68:71], v[212:215]
    ds_read_b64_tr_b16 v[234:235], v244 offset:63744
    s_waitcnt lgkmcnt(10)
    v_mfma_f32_16x16x32_bf16 v[216:219], v[228:231], v[64:67], v[216:219]
    ds_read_b64_tr_b16 v[236:237], v245 offset:63488
    v_mfma_f32_16x16x32_bf16 v[220:223], v[228:231], v[68:71], v[220:223]
    ds_read_b64_tr_b16 v[238:239], v245 offset:63744
    s_waitcnt lgkmcnt(10)
    v_mfma_f32_16x16x32_bf16 v[176:179], v[72:75], v[160:163], v[176:179]
    v_xor_b32 v244, 0x10000, v244
    v_xor_b32 v245, 0x10000, v245
    ds_read_b64_tr_b16 v[144:145], v4 offset:40960
    v_mfma_f32_16x16x32_bf16 v[180:183], v[76:79], v[160:163], v[180:183]
    ds_read_b64_tr_b16 v[146:147], v4 offset:41472
    s_waitcnt lgkmcnt(10)
    v_mfma_f32_16x16x32_bf16 v[184:187], v[72:75], v[164:167], v[184:187]
    ds_read_b64_tr_b16 v[148:149], v7 offset:40960
    v_mfma_f32_16x16x32_bf16 v[188:191], v[76:79], v[164:167], v[188:191]
    ds_read_b64_tr_b16 v[150:151], v7 offset:41472
    s_waitcnt lgkmcnt(10)
    v_mfma_f32_16x16x32_bf16 v[192:195], v[72:75], v[168:171], v[192:195]
    ds_read_b64_tr_b16 v[152:153], v8 offset:40960
    v_mfma_f32_16x16x32_bf16 v[196:199], v[76:79], v[168:171], v[196:199]
    ds_read_b64_tr_b16 v[154:155], v8 offset:41472
    s_waitcnt lgkmcnt(10)
    v_mfma_f32_16x16x32_bf16 v[200:203], v[72:75], v[172:175], v[200:203]
    ds_read_b64_tr_b16 v[156:157], v9 offset:40960
    v_mfma_f32_16x16x32_bf16 v[204:207], v[76:79], v[172:175], v[204:207]
    ds_read_b64_tr_b16 v[158:159], v9 offset:41472
    s_waitcnt lgkmcnt(10)
    v_mfma_f32_16x16x32_bf16 v[208:211], v[232:235], v[72:75], v[208:211]
    ds_read_b64_tr_b16 v[224:225], v244 offset:24576
    v_mfma_f32_16x16x32_bf16 v[212:215], v[232:235], v[76:79], v[212:215]
    ds_read_b64_tr_b16 v[226:227], v244 offset:24832
    s_waitcnt lgkmcnt(10)
    v_mfma_f32_16x16x32_bf16 v[216:219], v[236:239], v[72:75], v[216:219]
    ds_read_b64_tr_b16 v[228:229], v245 offset:24576
    v_mfma_f32_16x16x32_bf16 v[220:223], v[236:239], v[76:79], v[220:223]
    ds_read_b64_tr_b16 v[230:231], v245 offset:24832
    s_waitcnt lgkmcnt(10)
    v_mfma_f32_16x16x32_bf16 v[176:179], v[80:83], v[144:147], v[176:179]
    ds_read_b64_tr_b16 v[160:161], v4 offset:45056
    v_mfma_f32_16x16x32_bf16 v[180:183], v[84:87], v[144:147], v[180:183]
    ds_read_b64_tr_b16 v[162:163], v4 offset:45568
    s_waitcnt lgkmcnt(10)
    v_mfma_f32_16x16x32_bf16 v[184:187], v[80:83], v[148:151], v[184:187]
    ds_read_b64_tr_b16 v[164:165], v7 offset:45056
    v_mfma_f32_16x16x32_bf16 v[188:191], v[84:87], v[148:151], v[188:191]
    ds_read_b64_tr_b16 v[166:167], v7 offset:45568
    s_waitcnt lgkmcnt(10)
    v_mfma_f32_16x16x32_bf16 v[192:195], v[80:83], v[152:155], v[192:195]
    ds_read_b64_tr_b16 v[168:169], v8 offset:45056
    v_mfma_f32_16x16x32_bf16 v[196:199], v[84:87], v[152:155], v[196:199]
    ds_read_b64_tr_b16 v[170:171], v8 offset:45568
    s_waitcnt lgkmcnt(10)
    v_mfma_f32_16x16x32_bf16 v[200:203], v[80:83], v[156:159], v[200:203]
    ds_read_b64_tr_b16 v[172:173], v9 offset:45056
    v_mfma_f32_16x16x32_bf16 v[204:207], v[84:87], v[156:159], v[204:207]
    ds_read_b64_tr_b16 v[174:175], v9 offset:45568
    s_waitcnt lgkmcnt(10)
    v_mfma_f32_16x16x32_bf16 v[208:211], v[224:227], v[80:83], v[208:211]
    ds_read_b64_tr_b16 v[232:233], v244 offset:26624
    v_mfma_f32_16x16x32_bf16 v[212:215], v[224:227], v[84:87], v[212:215]
    ds_read_b64_tr_b16 v[234:235], v244 offset:26880
    s_waitcnt lgkmcnt(10)
    v_mfma_f32_16x16x32_bf16 v[216:219], v[228:231], v[80:83], v[216:219]
    ds_read_b64_tr_b16 v[236:237], v245 offset:26624
    v_mfma_f32_16x16x32_bf16 v[220:223], v[228:231], v[84:87], v[220:223]
    ds_read_b64_tr_b16 v[238:239], v245 offset:26880
    s_waitcnt lgkmcnt(10)
    v_mfma_f32_16x16x32_bf16 v[176:179], v[88:91], v[160:163], v[176:179]
    ds_read_b64_tr_b16 v[144:145], v4 offset:49152
    v_mfma_f32_16x16x32_bf16 v[180:183], v[92:95], v[160:163], v[180:183]
    ds_read_b64_tr_b16 v[146:147], v4 offset:49664
    s_waitcnt lgkmcnt(10)
    v_mfma_f32_16x16x32_bf16 v[184:187], v[88:91], v[164:167], v[184:187]
    ds_read_b64_tr_b16 v[148:149], v7 offset:49152
    v_mfma_f32_16x16x32_bf16 v[188:191], v[92:95], v[164:167], v[188:191]
    ds_read_b64_tr_b16 v[150:151], v7 offset:49664
    s_waitcnt lgkmcnt(10)
    v_mfma_f32_16x16x32_bf16 v[192:195], v[88:91], v[168:171], v[192:195]
    ds_read_b64_tr_b16 v[152:153], v8 offset:49152
    v_mfma_f32_16x16x32_bf16 v[196:199], v[92:95], v[168:171], v[196:199]
    ds_read_b64_tr_b16 v[154:155], v8 offset:49664
    s_waitcnt lgkmcnt(10)
    v_mfma_f32_16x16x32_bf16 v[200:203], v[88:91], v[172:175], v[200:203]
    ds_read_b64_tr_b16 v[156:157], v9 offset:49152
    v_mfma_f32_16x16x32_bf16 v[204:207], v[92:95], v[172:175], v[204:207]
    ds_read_b64_tr_b16 v[158:159], v9 offset:49664
    s_waitcnt lgkmcnt(10)
    v_mfma_f32_16x16x32_bf16 v[208:211], v[232:235], v[88:91], v[208:211]
    ds_read_b64_tr_b16 v[224:225], v244 offset:57344
    v_mfma_f32_16x16x32_bf16 v[212:215], v[232:235], v[92:95], v[212:215]
    ds_read_b64_tr_b16 v[226:227], v244 offset:57600
    s_waitcnt lgkmcnt(10)
    v_mfma_f32_16x16x32_bf16 v[216:219], v[236:239], v[88:91], v[216:219]
    ds_read_b64_tr_b16 v[228:229], v245 offset:57344
    v_mfma_f32_16x16x32_bf16 v[220:223], v[236:239], v[92:95], v[220:223]
    ds_read_b64_tr_b16 v[230:231], v245 offset:57600
    s_waitcnt lgkmcnt(10)
    v_mfma_f32_16x16x32_bf16 v[176:179], v[96:99], v[144:147], v[176:179]
    ds_read_b64_tr_b16 v[160:161], v4 offset:53248
    v_mfma_f32_16x16x32_bf16 v[180:183], v[100:103], v[144:147], v[180:183]
    ds_read_b64_tr_b16 v[162:163], v4 offset:53760
    s_waitcnt lgkmcnt(10)
    v_mfma_f32_16x16x32_bf16 v[184:187], v[96:99], v[148:151], v[184:187]
    ds_read_b64_tr_b16 v[164:165], v7 offset:53248
    v_mfma_f32_16x16x32_bf16 v[188:191], v[100:103], v[148:151], v[188:191]
    ds_read_b64_tr_b16 v[166:167], v7 offset:53760
    s_waitcnt lgkmcnt(10)
    v_mfma_f32_16x16x32_bf16 v[192:195], v[96:99], v[152:155], v[192:195]
    ds_read_b64_tr_b16 v[168:169], v8 offset:53248
    v_mfma_f32_16x16x32_bf16 v[196:199], v[100:103], v[152:155], v[196:199]
    ds_read_b64_tr_b16 v[170:171], v8 offset:53760
    s_waitcnt lgkmcnt(10)
    v_mfma_f32_16x16x32_bf16 v[200:203], v[96:99], v[156:159], v[200:203]
    ds_read_b64_tr_b16 v[172:173], v9 offset:53248
    v_mfma_f32_16x16x32_bf16 v[204:207], v[100:103], v[156:159], v[204:207]
    ds_read_b64_tr_b16 v[174:175], v9 offset:53760
    s_waitcnt lgkmcnt(10)
    v_mfma_f32_16x16x32_bf16 v[208:211], v[224:227], v[96:99], v[208:211]
    ds_read_b64_tr_b16 v[232:233], v244 offset:59392
    v_mfma_f32_16x16x32_bf16 v[212:215], v[224:227], v[100:103], v[212:215]
    ds_read_b64_tr_b16 v[234:235], v244 offset:59648
    s_waitcnt lgkmcnt(10)
    v_mfma_f32_16x16x32_bf16 v[216:219], v[228:231], v[96:99], v[216:219]
    ds_read_b64_tr_b16 v[236:237], v245 offset:59392
    v_mfma_f32_16x16x32_bf16 v[220:223], v[228:231], v[100:103], v[220:223]
    ds_read_b64_tr_b16 v[238:239], v245 offset:59648
    s_waitcnt lgkmcnt(10)
    v_mfma_f32_16x16x32_bf16 v[176:179], v[104:107], v[160:163], v[176:179]
    v_and_b32 v250, 3, v1
    v_lshlrev_b32 v250, 2, v250
    v_add_u32 v250, 163776, v250
    s_mov_b32 s59, 2097152
L_lw_12:
    ds_read_b32 v251, v250 offset:16
    s_waitcnt lgkmcnt(0)
    v_cmp_gt_u32 vcc, 4, v251
    s_cbranch_vccz L_lw_12_ok
    s_sleep 1
    s_sub_u32 s59, s59, 1
    s_cmp_lg_u32 s59, 0
    s_cbranch_scc1 L_lw_12
L_lw_12_ok:
    v_xor_b32 v4, 0x10000, v4
    v_xor_b32 v7, 0x10000, v7
    v_xor_b32 v8, 0x10000, v8
    v_xor_b32 v9, 0x10000, v9
    v_xor_b32 v244, 0x10000, v244
    v_xor_b32 v245, 0x10000, v245
    ds_read_b64_tr_b16 v[144:145], v4 offset:0
    v_mfma_f32_16x16x32_bf16 v[180:183], v[108:111], v[160:163], v[180:183]
    ds_read_b64_tr_b16 v[146:147], v4 offset:512
    s_waitcnt lgkmcnt(10)
    v_mfma_f32_16x16x32_bf16 v[184:187], v[104:107], v[164:167], v[184:187]
    ds_read_b64_tr_b16 v[148:149], v7 offset:0
    v_mfma_f32_16x16x32_bf16 v[188:191], v[108:111], v[164:167], v[188:191]
    ds_read_b64_tr_b16 v[150:151], v7 offset:512
    s_waitcnt lgkmcnt(10)
    v_mfma_f32_16x16x32_bf16 v[192:195], v[104:107], v[168:171], v[192:195]
    ds_read_b64_tr_b16 v[152:153], v8 offset:0
    v_mfma_f32_16x16x32_bf16 v[196:199], v[108:111], v[168:171], v[196:199]
    ds_read_b64_tr_b16 v[154:155], v8 offset:512
    s_waitcnt lgkmcnt(10)
    v_mfma_f32_16x16x32_bf16 v[200:203], v[104:107], v[172:175], v[200:203]
    ds_read_b64_tr_b16 v[156:157], v9 offset:0
    v_mfma_f32_16x16x32_bf16 v[204:207], v[108:111], v[172:175], v[204:207]
    ds_read_b64_tr_b16 v[158:159], v9 offset:512
    s_waitcnt lgkmcnt(10)
    v_mfma_f32_16x16x32_bf16 v[208:211], v[232:235], v[104:107], v[208:211]
    ds_read_b64_tr_b16 v[224:225], v244 offset:24576
    v_mfma_f32_16x16x32_bf16 v[212:215], v[232:235], v[108:111], v[212:215]
    ds_read_b64_tr_b16 v[226:227], v244 offset:24832
    s_waitcnt lgkmcnt(10)
    v_mfma_f32_16x16x32_bf16 v[216:219], v[236:239], v[104:107], v[216:219]
    ds_read_b64_tr_b16 v[228:229], v245 offset:24576
    v_mfma_f32_16x16x32_bf16 v[220:223], v[236:239], v[108:111], v[220:223]
    ds_read_b64_tr_b16 v[230:231], v245 offset:24832
    s_waitcnt lgkmcnt(10)
    v_mfma_f32_16x16x32_bf16 v[176:179], v[112:115], v[144:147], v[176:179]
    ds_read_b64_tr_b16 v[160:161], v4 offset:4096
    v_mfma_f32_16x16x32_bf16 v[180:183], v[116:119], v[144:147], v[180:183]
    ds_read_b64_tr_b16 v[162:163], v4 offset:4608
    s_waitcnt lgkmcnt(10)
    v_mfma_f32_16x16x32_bf16 v[184:187], v[112:115], v[148:151], v[184:187]
    ds_read_b64_tr_b16 v[164:165], v7 offset:4096
    v_mfma_f32_16x16x32_bf16 v[188:191], v[116:119], v[148:151], v[188:191]
    ds_read_b64_tr_b16 v[166:167], v7 offset:4608
    s_waitcnt lgkmcnt(10)
    v_mfma_f32_16x16x32_bf16 v[192:195], v[112:115], v[152:155], v[192:195]
    ds_read_b64_tr_b16 v[168:169], v8 offset:4096
    v_mfma_f32_16x16x32_bf16 v[196:199], v[116:119], v[152:155], v[196:199]
    ds_read_b64_tr_b16 v[170:171], v8 offset:4608
    s_waitcnt lgkmcnt(10)
    v_mfma_f32_16x16x32_bf16 v[200:203], v[112:115], v[156:159], v[200:203]
    ds_read_b64_tr_b16 v[172:173], v9 offset:4096
    v_mfma_f32_16x16x32_bf16 v[204:207], v[116:119], v[156:159], v[204:207]
    ds_read_b64_tr_b16 v[174:175], v9 offset:4608
    s_waitcnt lgkmcnt(10)
    v_mfma_f32_16x16x32_bf16 v[208:211], v[224:227], v[112:115], v[208:211]
    ds_read_b64_tr_b16 v[232:233], v244 offset:26624
    v_mfma_f32_16x16x32_bf16 v[212:215], v[224:227], v[116:119], v[212:215]
    ds_read_b64_tr_b16 v[234:235], v244 offset:26880
    s_waitcnt lgkmcnt(10)
    v_mfma_f32_16x16x32_bf16 v[216:219], v[228:231], v[112:115], v[216:219]
    ds_read_b64_tr_b16 v[236:237], v245 offset:26624
    v_mfma_f32_16x16x32_bf16 v[220:223], v[228:231], v[116:119], v[220:223]
    ds_read_b64_tr_b16 v[238:239], v245 offset:26880
    s_waitcnt lgkmcnt(10)
    v_mfma_f32_16x16x32_bf16 v[176:179], v[120:123], v[160:163], v[176:179]
    ds_read_b64_tr_b16 v[144:145], v4 offset:8192
    v_mfma_f32_16x16x32_bf16 v[180:183], v[124:127], v[160:163], v[180:183]
    ds_read_b64_tr_b16 v[146:147], v4 offset:8704
    s_waitcnt lgkmcnt(10)
    v_mfma_f32_16x16x32_bf16 v[184:187], v[120:123], v[164:167], v[184:187]
    ds_read_b64_tr_b16 v[148:149], v7 offset:8192
    v_mfma_f32_16x16x32_bf16 v[188:191], v[124:127], v[164:167], v[188:191]
    ds_read_b64_tr_b16 v[150:151], v7 offset:8704
    s_waitcnt lgkmcnt(10)
    v_mfma_f32_16x16x32_bf16 v[192:195], v[120:123], v[168:171], v[192:195]
    ds_read_b64_tr_b16 v[152:153], v8 offset:8192
    v_mfma_f32_16x16x32_bf16 v[196:199], v[124:127], v[168:171], v[196:199]
    ds_read_b64_tr_b16 v[154:155], v8 offset:8704
    s_waitcnt lgkmcnt(10)
    v_mfma_f32_16x16x32_bf16 v[200:203], v[120:123], v[172:175], v[200:203]
    ds_read_b64_tr_b16 v[156:157], v9 offset:8192
    v_mfma_f32_16x16x32_bf16 v[204:207], v[124:127], v[172:175], v[204:207]
    ds_read_b64_tr_b16 v[158:159], v9 offset:8704
    s_waitcnt lgkmcnt(10)
    v_mfma_f32_16x16x32_bf16 v[208:211], v[232:235], v[120:123], v[208:211]
    ds_read_b64_tr_b16 v[224:225], v244 offset:57344
    v_mfma_f32_16x16x32_bf16 v[212:215], v[232:235], v[124:127], v[212:215]
    ds_read_b64_tr_b16 v[226:227], v244 offset:57600
    s_waitcnt lgkmcnt(10)
    v_mfma_f32_16x16x32_bf16 v[216:219], v[236:239], v[120:123], v[216:219]
    ds_read_b64_tr_b16 v[228:229], v245 offset:57344
    v_mfma_f32_16x16x32_bf16 v[220:223], v[236:239], v[124:127], v[220:223]
    ds_read_b64_tr_b16 v[230:231], v245 offset:57600
    s_waitcnt lgkmcnt(10)
    v_mfma_f32_16x16x32_bf16 v[176:179], v[128:131], v[144:147], v[176:179]
    ds_read_b64_tr_b16 v[160:161], v4 offset:12288
    v_mfma_f32_16x16x32_bf16 v[180:183], v[132:135], v[144:147], v[180:183]
    ds_read_b64_tr_b16 v[162:163], v4 offset:12800
    s_waitcnt lgkmcnt(10)
    v_mfma_f32_16x16x32_bf16 v[184:187], v[128:131], v[148:151], v[184:187]
    ds_read_b64_tr_b16 v[164:165], v7 offset:12288
    v_mfma_f32_16x16x32_bf16 v[188:191], v[132:135], v[148:151], v[188:191]
    ds_read_b64_tr_b16 v[166:167], v7 offset:12800
    s_waitcnt lgkmcnt(10)
    v_mfma_f32_16x16x32_bf16 v[192:195], v[128:131], v[152:155], v[192:195]
    ds_read_b64_tr_b16 v[168:169], v8 offset:12288
    v_mfma_f32_16x16x32_bf16 v[196:199], v[132:135], v[152:155], v[196:199]
    ds_read_b64_tr_b16 v[170:171], v8 offset:12800
    s_waitcnt lgkmcnt(10)
    v_mfma_f32_16x16x32_bf16 v[200:203], v[128:131], v[156:159], v[200:203]
    ds_read_b64_tr_b16 v[172:173], v9 offset:12288
    v_mfma_f32_16x16x32_bf16 v[204:207], v[132:135], v[156:159], v[204:207]
    ds_read_b64_tr_b16 v[174:175], v9 offset:12800
    s_waitcnt lgkmcnt(10)
    v_mfma_f32_16x16x32_bf16 v[208:211], v[224:227], v[128:131], v[208:211]
    ds_read_b64_tr_b16 v[232:233], v244 offset:59392
    v_mfma_f32_16x16x32_bf16 v[212:215], v[224:227], v[132:135], v[212:215]
    ds_read_b64_tr_b16 v[234:235], v244 offset:59648
    s_waitcnt lgkmcnt(10)
    v_mfma_f32_16x16x32_bf16 v[216:219], v[228:231], v[128:131], v[216:219]
    ds_read_b64_tr_b16 v[236:237], v245 offset:59392
    v_mfma_f32_16x16x32_bf16 v[220:223], v[228:231], v[132:135], v[220:223]
    ds_read_b64_tr_b16 v[238:239], v245 offset:59648
    s_waitcnt lgkmcnt(10)
    v_mfma_f32_16x16x32_bf16 v[176:179], v[136:139], v[160:163], v[176:179]
    v_mfma_f32_16x16x32_bf16 v[180:183], v[140:143], v[160:163], v[180:183]
    s_waitcnt lgkmcnt(8)
    v_mfma_f32_16x16x32_bf16 v[184:187], v[136:139], v[164:167], v[184:187]
    v_mfma_f32_16x16x32_bf16 v[188:191], v[140:143], v[164:167], v[188:191]
    s_waitcnt lgkmcnt(6)
    v_mfma_f32_16x16x32_bf16 v[192:195], v[136:139], v[168:171], v[192:195]
    v_mfma_f32_16x16x32_bf16 v[196:199], v[140:143], v[168:171], v[196:199]
    s_waitcnt lgkmcnt(4)
    v_mfma_f32_16x16x32_bf16 v[200:203], v[136:139], v[172:175], v[200:203]
    v_mfma_f32_16x16x32_bf16 v[204:207], v[140:143], v[172:175], v[204:207]
    s_waitcnt lgkmcnt(2)
    v_mfma_f32_16x16x32_bf16 v[208:211], v[232:235], v[136:139], v[208:211]
    v_mfma_f32_16x16x32_bf16 v[212:215], v[232:235], v[140:143], v[212:215]
    s_waitcnt lgkmcnt(0)
    v_mfma_f32_16x16x32_bf16 v[216:219], v[236:239], v[136:139], v[216:219]
    v_mfma_f32_16x16x32_bf16 v[220:223], v[236:239], v[140:143], v[220:223]
    s_nop 3
    v_cvt_pk_bf16_f32 v144, v176, v177
    v_cvt_pk_bf16_f32 v145, v178, v179
    v_cvt_pk_bf16_f32 v146, v184, v185
    v_cvt_pk_bf16_f32 v147, v186, v187
    v_cvt_pk_bf16_f32 v148, v180, v181
    v_cvt_pk_bf16_f32 v149, v182, v183
    v_cvt_pk_bf16_f32 v150, v188, v189
    v_cvt_pk_bf16_f32 v151, v190, v191
    v_permlane16_swap_b32 v144, v146
    v_permlane16_swap_b32 v145, v147
    s_add_u32 s59, s70, 8388608
    buffer_store_dwordx4 v[144:147], v3, s[16:19], s59 offen offset:1024 sc1
    v_cvt_pk_bf16_f32 v152, v192, v193
    v_cvt_pk_bf16_f32 v153, v194, v195
    v_cvt_pk_bf16_f32 v154, v200, v201
    v_cvt_pk_bf16_f32 v155, v202, v203
    v_permlane16_swap_b32 v148, v150
    v_permlane16_swap_b32 v149, v151
    s_add_u32 s59, s70, 8388608
    buffer_store_dwordx4 v[148:151], v3, s[16:19], s59 offen offset:1536 sc1
    v_cvt_pk_bf16_f32 v156, v196, v197
    v_cvt_pk_bf16_f32 v157, v198, v199
    v_cvt_pk_bf16_f32 v158, v204, v205
    v_cvt_pk_bf16_f32 v159, v206, v207
    v_permlane16_swap_b32 v152, v154
    v_permlane16_swap_b32 v153, v155
    s_add_u32 s59, s70, 8650752
    buffer_store_dwordx4 v[152:155], v3, s[16:19], s59 offen offset:1024 sc1
    s_nop 1
    v_permlane16_swap_b32 v156, v158
    v_permlane16_swap_b32 v157, v159
    s_add_u32 s59, s70, 8650752
    buffer_store_dwordx4 v[156:159], v3, s[16:19], s59 offen offset:1536 sc1
L_p1_end:
    v_mul_f32 v208, s69, v208
    v_mul_f32 v209, s69, v209
    v_mul_f32 v210, s69, v210
    v_mul_f32 v211, s69, v211
    v_mul_f32 v212, s69, v212
    v_mul_f32 v213, s69, v213
    v_mul_f32 v214, s69, v214
    v_mul_f32 v215, s69, v215
    v_mul_f32 v216, s69, v216
    v_mul_f32 v217, s69, v217
    v_mul_f32 v218, s69, v218
    v_mul_f32 v219, s69, v219
    v_mul_f32 v220, s69, v220
    v_mul_f32 v221, s69, v221
    v_mul_f32 v222, s69, v222
    v_mul_f32 v223, s69, v223
    v_cvt_pk_bf16_f32 v208, v208, v209
    v_cvt_pk_bf16_f32 v209, v210, v211
    v_cvt_pk_bf16_f32 v210, v212, v213
    v_cvt_pk_bf16_f32 v211, v214, v215
    v_cvt_pk_bf16_f32 v212, v216, v217
    v_cvt_pk_bf16_f32 v213, v218, v219
    v_cvt_pk_bf16_f32 v214, v220, v221
    v_cvt_pk_bf16_f32 v215, v222, v223
    v_permlane16_swap_b32 v208, v210
    v_permlane16_swap_b32 v209, v211
    v_permlane16_swap_b32 v212, v214
    v_permlane16_swap_b32 v213, v215
    ds_write_b128 v248, v[208:211] offset:8192
    ds_write_b128 v248, v[212:215] offset:12288
    s_waitcnt lgkmcnt(0)
    v_mov_b32 v250, 163776
    v_mov_b32 v251, 1
    s_mov_b64 exec, 1
    ds_add_u32 v250, v251 offset:40
    s_mov_b64 exec, -1
    v_mov_b32 v92, 0
    v_mov_b32 v93, 0
    v_mov_b32 v94, 0
    v_mov_b32 v95, 0
    v_mov_b32 v146, 0xff800000
    v_mov_b32 v52, 0xdddddddd
    v_mfma_f32_32x32x16_bf16 v[60:75], v[92:95], v[92:95], 0
    v_mfma_f32_32x32x16_bf16 v[76:91], v[92:95], v[92:95], 0
    v_mfma_f32_32x32x16_bf16 v[200:215], v[92:95], v[92:95], 0
    v_mfma_f32_32x32x16_bf16 v[216:231], v[92:95], v[92:95], 0
    v_add_u32 v148, 147456, v2
    ds_read_b128 v[108:111], v148 offset:0
    ds_read_b128 v[112:115], v148 offset:1024
    ds_read_b128 v[116:119], v148 offset:2048
    ds_read_b128 v[120:123], v148 offset:3072
    ds_read_b128 v[124:127], v148 offset:11776
    ds_read_b128 v[128:131], v148 offset:12800
    ds_read_b128 v[132:135], v148 offset:13824
    ds_read_b128 v[136:139], v148 offset:14848
L_p2:
    s_lshl_b32 s56, s55, 2
    s_and_b32 s59, s3, 1
    s_lshl_b32 s59, s59, 1
    s_add_u32 s56, s56, s59
    s_and_b32 s59, s52, 1
    s_add_u32 s69, s59, s56
    s_lshr_b32 s56, s52, 2
    s_lshr_b32 s57, s3, 1
    s_lshl_b32 s57, s57, 2
    s_lshr_b32 s59, s52, 1
    s_add_u32 s58, s57, s59
    s_lshl_b32 s59, s69, 6
    s_add_u32 s65, s59, s58
    s_lshl_b32 s65, s65, 10
    s_and_b32 s33, s52, 2
    s_add_u32 s64, s59, s57
    s_add_u32 s64, s64, s33
    s_lshl_b32 s64, s64, 10
    s_mov_b32 s24, 0x0000ffff
    s_mov_b32 s25, 0x0000ffff
    s_lshl_b32 s60, s69, 17
    s_add_u32 s60, s60, 4194304
    v_add_u32 v144, s60, v2
    v_lshrrev_b32 v151, 5, v1
    v_lshlrev_b32 v151, 8, v151
    v_and_b32 v5, 15, v1
    v_lshl_add_u32 v5, v5, 4, v151
    v_add_u32 v145, s60, v5
    s_add_u32 s60, s60, 4194304
    v_add_u32 v149, s60, v2
    v_add_u32 v150, s60, v5
    s_mov_b32 s60, 0x00110000
    s_mov_b32 s61, 0x00110000
    s_lshl_b32 s59, s55, 17
    s_add_u32 s59, s59, 18874368
    v_mov_b32 v148, s59
    v_mov_b32 v151, 0x7f000000
    v_cndmask_b32 v148, v151, v148, s[60:61]
    v_cndmask_b32 v145, v148, v145, s[24:25]
    v_cndmask_b32 v150, v148, v150, s[24:25]
    s_lshl_b32 s66, s57, 11
    s_and_b32 s66, s66, 0xffff
    s_lshl_b32 s60, s33, 15
    s_add_u32 s66, s66, s60
    s_mul_i32 s60, s56, 28672
    s_add_u32 s66, s66, s60
    s_and_b32 s66, s66, 0x1ffff
    s_lshl_b32 s32, s53, 2
    s_and_b32 s59, s54, 3
    s_add_u32 s32, s32, s59
    s_lshr_b32 s12, s54, 2
    s_and_b32 s13, s52, 1
    s_lshr_b32 s14, s52, 1
    s_lshl_b32 s32, s32, 1
    s_add_u32 s32, s32, s13
    s_cmp_lg_u32 s56, 0
    s_cselect_b32 s8, s36, s42
    s_cselect_b32 s9, s37, s43
    s_mov_b32 s10, 0x80000
    s_mov_b32 s11, 0x00020000
    s_mov_b32 s4, s46
    s_mov_b32 s5, s47
    s_mov_b32 s6, 0x200000
    s_mov_b32 s7, 0x00020000
    s_and_b32 s38, s14, 1
    s_lshl_b32 s38, s38, 18
    s_lshl_b32 s59, s13, 13
    s_add_u32 s38, s38, s59
    s_lshl_b32 s59, s12, 7
    s_add_u32 s38, s38, s59
    s_lshl_b32 s39, s14, 15
    s_lshl_b32 s59, s13, 10
    s_add_u32 s39, s39, s59
    v_lshrrev_b32 v151, 3, v1
    v_lshlrev_b32 v7, 10, v151
    v_bfe_u32 v151, v1, 4, 1
    v_lshlrev_b32 v151, 2, v151
    v_and_b32 v5, 7, v1
    v_xor_b32 v151, v151, v5
    v_lshl_add_u32 v7, v151, 4, v7
    v_add_u32 v7, s38, v7
    v_add_u32 v4, 0x20000, v7
    s_lshl_b32 s38, s12, 14
    v_and_b32 v6, 31, v1
    v_lshlrev_b32 v6, 2, v6
    s_mul_i32 s60, s13, 10240
    s_add_u32 s60, s60, 131072
    s_mul_i32 s61, s33, 2560
    s_add_u32 s59, s60, s61
    v_add_u32 v140, s59, v2
    v_lshl_add_u32 v55, v1, 2, s59
    s_add_u32 s59, s60, 5120
    s_sub_u32 s59, s59, s61
    v_add_u32 v141, s59, v2
    v_lshl_add_u32 v56, v1, 2, s59
    s_lshl_b32 s60, s13, 2
    s_add_u32 s60, s60, 163824
    v_mov_b32 v147, s60
    s_mov_b32 s26, 0x5f800000
    s_mov_b32 s27, 0x7f800000
    s_mov_b32 s28, 0
    s_mov_b32 s29, 0
    s_cmp_lg_u32 s56, 0
    s_cselect_b32 s67, 9, 7
    s_cselect_b32 s70, 3, 2
    s_cselect_b32 s71, 4, 6
    s_mov_b32 s15, 0
    s_mov_b32 s44, 16384
    s_add_u32 s57, s57, s33
    s_cmp_eq_u32 s56, 0
    s_cbranch_scc1 L_p2_late
    s_waitcnt vmcnt(0)
    v_mov_b32 v11, 4
    ds_write_b32 v10, v11
    v_mov_b32 v250, 163776
    s_mov_b32 s59, 2097152
L_lw_13:
    ds_read_b32 v251, v250 offset:56
    s_waitcnt lgkmcnt(0)
    v_cmp_gt_u32 vcc, 4, v251
    s_cbranch_vccz L_lw_13_ok
    s_sleep 1
    s_sub_u32 s59, s59, 1
    s_cmp_lg_u32 s59, 0
    s_cbranch_scc1 L_lw_13
L_lw_13_ok:
    s_lshl_b32 s60, s13, 12
    s_add_u32 s60, s60, 131072
    s_lshl_b32 s61, s33, 10
    s_add_u32 s61, s61, s60
    v_add_u32 v151, s61, v2
    v_xor_b32 v5, 2048, v151
    ds_read_b128 v[8:11], v151 offset:0
    ds_read_b128 v[12:15], v151 offset:1024
    ds_read_b128 v[232:235], v5 offset:0
    ds_read_b128 v[236:239], v5 offset:1024
    s_waitcnt lgkmcnt(0)
    v_mov_b32 v250, 163776
    v_mov_b32 v251, 1
    s_mov_b64 exec, 1
    ds_add_u32 v250, v251 offset:60
    s_mov_b64 exec, -1
    s_cmp_lg_u32 s52, 4
    s_cbranch_scc1 L_ps_14_w
    s_lshl_b32 s60, s55, 12
    s_add_u32 s60, s60, 17039360
    v_and_b32 v250, 31, v1
    v_lshlrev_b32 v250, 7, v250
    s_mov_b32 s59, 262144
L_poll_15:
    buffer_load_dwordx2 v[252:253], v250, s[16:19], s60 offen sc1
    s_waitcnt vmcnt(0)
    v_cmp_ne_u64 vcc, s[30:31], v[252:253]
    s_cbranch_vccz L_poll_15_ok
    s_sleep 2
    s_sub_u32 s59, s59, 1
    s_cmp_lg_u32 s59, 0
    s_cbranch_scc1 L_poll_15
L_poll_15_ok:
    v_mov_b32 v250, 163776
    v_mov_b32 v251, 1
    s_mov_b64 exec, 1
    ds_add_u32 v250, v251 offset:36
    s_mov_b64 exec, -1
    s_branch L_ps_14_d
L_ps_14_w:
    v_mov_b32 v250, 163776
    s_mov_b32 s59, 2097152
L_lw_16:
    ds_read_b32 v251, v250 offset:36
    s_waitcnt lgkmcnt(0)
    v_cmp_gt_u32 vcc, 1, v251
    s_cbranch_vccz L_lw_16_ok
    s_sleep 1
    s_sub_u32 s59, s59, 1
    s_cmp_lg_u32 s59, 0
    s_cbranch_scc1 L_lw_16
L_lw_16_ok:
L_ps_14_d:
    buffer_load_dwordx4 v[92:95], v144, s[16:19], s66 offen offset:0 sc1
    buffer_load_dwordx4 v[96:99], v145, s[16:19], s66 offen offset:1024 sc1
    buffer_load_dwordx4 v[100:103], v145, s[16:19], s66 offen offset:1536 sc1
    buffer_load_dwordx4 v[104:107], v144, s[16:19], s66 offen offset:2048 sc1
    buffer_load_dwordx4 v[108:111], v145, s[16:19], s66 offen offset:3072 sc1
    buffer_load_dwordx4 v[112:115], v145, s[16:19], s66 offen offset:3584 sc1
    s_setprio 3
    s_mov_b32 s67, 7
    s_waitcnt vmcnt(3)
    v_mfma_f32_32x32x16_bf16 v[20:35], v[92:95], v[8:11], 0
    s_nop 11
    v_exp_f32 v20, v20
    v_exp_f32 v21, v21
    s_add_u32 s66, s66, 4096
    s_and_b32 s66, s66, 0x1ffff
    buffer_load_dwordx4 v[116:119], v144, s[16:19], s66 offen offset:0 sc1
    v_exp_f32 v22, v22
    v_exp_f32 v23, v23
    v_exp_f32 v24, v24
    v_mfma_f32_32x32x16_bf16 v[36:51], v[92:95], v[12:15], 0
    buffer_load_dwordx4 v[120:123], v145, s[16:19], s66 offen offset:1024 sc1
    v_exp_f32 v25, v25
    v_exp_f32 v26, v26
    v_exp_f32 v27, v27
    v_exp_f32 v28, v28
    v_exp_f32 v29, v29
    v_exp_f32 v30, v30
    v_smfmac_f32_32x32x32_bf16 v[60:75], v[96:99], v[20:27], v52
    buffer_load_dwordx4 v[124:127], v145, s[16:19], s66 offen offset:1536 sc1
    v_exp_f32 v31, v31
    v_exp_f32 v32, v32
    v_exp_f32 v33, v33
    v_exp_f32 v34, v34
    v_exp_f32 v35, v35
    v_exp_f32 v36, v36
    v_exp_f32 v37, v37
    v_smfmac_f32_32x32x32_bf16 v[60:75], v[100:103], v[28:35], v52
    buffer_load_dwordx4 v[128:131], v144, s[16:19], s66 offen offset:2048 sc1
    v_exp_f32 v38, v38
    v_exp_f32 v39, v39
    v_exp_f32 v40, v40
    v_mfma_f32_32x32x16_bf16 v[20:35], v[92:95], v[232:235], 0
    buffer_load_dwordx4 v[132:135], v145, s[16:19], s66 offen offset:3072 sc1
    v_exp_f32 v41, v41
    v_exp_f32 v42, v42
    v_exp_f32 v43, v43
    v_exp_f32 v44, v44
    v_exp_f32 v45, v45
    v_exp_f32 v46, v46
    v_smfmac_f32_32x32x32_bf16 v[76:91], v[96:99], v[36:43], v52
    buffer_load_dwordx4 v[136:139], v145, s[16:19], s66 offen offset:3584 sc1
    v_exp_f32 v47, v47
    v_exp_f32 v48, v48
    v_exp_f32 v49, v49
    v_exp_f32 v50, v50
    v_exp_f32 v51, v51
    v_exp_f32 v20, v20
    v_exp_f32 v21, v21
    v_smfmac_f32_32x32x32_bf16 v[76:91], v[100:103], v[44:51], v52
    s_add_u32 s66, s66, 4096
    s_and_b32 s66, s66, 0x1ffff
    buffer_load_dwordx4 v[152:155], v144, s[16:19], s66 offen offset:0 sc1
    v_exp_f32 v22, v22
    v_exp_f32 v23, v23
    v_exp_f32 v24, v24
    v_mfma_f32_32x32x16_bf16 v[36:51], v[92:95], v[236:239], 0
    buffer_load_dwordx4 v[156:159], v145, s[16:19], s66 offen offset:1024 sc1
    v_exp_f32 v25, v25
    v_exp_f32 v26, v26
    v_exp_f32 v27, v27
    v_exp_f32 v28, v28
    v_exp_f32 v29, v29
    v_exp_f32 v30, v30
    v_smfmac_f32_32x32x32_bf16 v[200:215], v[96:99], v[20:27], v52
    buffer_load_dwordx4 v[160:163], v145, s[16:19], s66 offen offset:1536 sc1
    v_exp_f32 v31, v31
    v_exp_f32 v32, v32
    v_exp_f32 v33, v33
    v_exp_f32 v34, v34
    v_exp_f32 v35, v35
    v_exp_f32 v36, v36
    v_exp_f32 v37, v37
    v_smfmac_f32_32x32x32_bf16 v[200:215], v[100:103], v[28:35], v52
    s_waitcnt vmcnt(9)
    buffer_load_dwordx4 v[164:167], v144, s[16:19], s66 offen offset:2048 sc1
    v_exp_f32 v38, v38
    v_exp_f32 v39, v39
    v_exp_f32 v40, v40
    v_mfma_f32_32x32x16_bf16 v[20:35], v[104:107], v[8:11], 0
    buffer_load_dwordx4 v[168:171], v145, s[16:19], s66 offen offset:3072 sc1
    v_exp_f32 v41, v41
    v_exp_f32 v42, v42
    v_exp_f32 v43, v43
    v_exp_f32 v44, v44
    v_exp_f32 v45, v45
    v_exp_f32 v46, v46
    v_smfmac_f32_32x32x32_bf16 v[216:231], v[96:99], v[36:43], v52
    buffer_load_dwordx4 v[172:175], v145, s[16:19], s66 offen offset:3584 sc1
    v_exp_f32 v47, v47
    v_exp_f32 v48, v48
    v_exp_f32 v49, v49
    v_exp_f32 v50, v50
    v_exp_f32 v51, v51
    v_exp_f32 v20, v20
    v_exp_f32 v21, v21
    v_smfmac_f32_32x32x32_bf16 v[216:231], v[100:103], v[44:51], v52
    s_add_u32 s66, s66, 4096
    s_and_b32 s66, s66, 0x1ffff
    buffer_load_dwordx4 v[176:179], v144, s[16:19], s66 offen offset:0 sc1
    v_exp_f32 v22, v22
    v_exp_f32 v23, v23
    v_exp_f32 v24, v24
    v_mfma_f32_32x32x16_bf16 v[36:51], v[104:107], v[12:15], 0
    buffer_load_dwordx4 v[180:183], v145, s[16:19], s66 offen offset:1024 sc1
    v_exp_f32 v25, v25
    v_exp_f32 v26, v26
    v_exp_f32 v27, v27
    v_exp_f32 v28, v28
    v_exp_f32 v29, v29
    v_exp_f32 v30, v30
    v_smfmac_f32_32x32x32_bf16 v[60:75], v[108:111], v[20:27], v52
    buffer_load_dwordx4 v[184:187], v145, s[16:19], s66 offen offset:1536 sc1
    v_exp_f32 v31, v31
    v_exp_f32 v32, v32
    v_exp_f32 v33, v33
    v_exp_f32 v34, v34
    v_exp_f32 v35, v35
    v_exp_f32 v36, v36
    v_exp_f32 v37, v37
    v_smfmac_f32_32x32x32_bf16 v[60:75], v[112:115], v[28:35], v52
    v_exp_f32 v38, v38
    v_exp_f32 v39, v39
    v_exp_f32 v40, v40
    v_mfma_f32_32x32x16_bf16 v[20:35], v[104:107], v[232:235], 0
    v_exp_f32 v41, v41
    v_exp_f32 v42, v42
    v_exp_f32 v43, v43
    v_exp_f32 v44, v44
    v_exp_f32 v45, v45
    v_exp_f32 v46, v46
    v_smfmac_f32_32x32x32_bf16 v[76:91], v[108:111], v[36:43], v52
    v_exp_f32 v47, v47
    v_exp_f32 v48, v48
    v_exp_f32 v49, v49
    v_exp_f32 v50, v50
    v_exp_f32 v51, v51
    v_exp_f32 v20, v20
    v_exp_f32 v21, v21
    v_smfmac_f32_32x32x32_bf16 v[76:91], v[112:115], v[44:51], v52
    v_exp_f32 v22, v22
    v_exp_f32 v23, v23
    v_exp_f32 v24, v24
    v_mfma_f32_32x32x16_bf16 v[36:51], v[104:107], v[236:239], 0
    v_exp_f32 v25, v25
    v_exp_f32 v26, v26
    v_exp_f32 v27, v27
    v_exp_f32 v28, v28
    v_exp_f32 v29, v29
    v_exp_f32 v30, v30
    v_smfmac_f32_32x32x32_bf16 v[200:215], v[108:111], v[20:27], v52
    v_exp_f32 v31, v31
    v_exp_f32 v32, v32
    v_exp_f32 v33, v33
    v_exp_f32 v34, v34
    v_exp_f32 v35, v35
    v_exp_f32 v36, v36
    v_exp_f32 v37, v37
    v_smfmac_f32_32x32x32_bf16 v[200:215], v[112:115], v[28:35], v52
    s_waitcnt vmcnt(12)
    v_exp_f32 v38, v38
    v_exp_f32 v39, v39
    v_exp_f32 v40, v40
    v_mfma_f32_32x32x16_bf16 v[20:35], v[116:119], v[8:11], 0
    v_exp_f32 v41, v41
    v_exp_f32 v42, v42
    v_exp_f32 v43, v43
    v_exp_f32 v44, v44
    v_exp_f32 v45, v45
    v_exp_f32 v46, v46
    v_smfmac_f32_32x32x32_bf16 v[216:231], v[108:111], v[36:43], v52
    v_exp_f32 v47, v47
    v_exp_f32 v48, v48
    v_exp_f32 v49, v49
    v_exp_f32 v50, v50
    v_exp_f32 v51, v51
    v_exp_f32 v20, v20
    v_exp_f32 v21, v21
    v_smfmac_f32_32x32x32_bf16 v[216:231], v[112:115], v[44:51], v52
    v_exp_f32 v22, v22
    v_exp_f32 v23, v23
    v_exp_f32 v24, v24
    v_mfma_f32_32x32x16_bf16 v[36:51], v[116:119], v[12:15], 0
    v_exp_f32 v25, v25
    v_exp_f32 v26, v26
    v_exp_f32 v27, v27
    v_exp_f32 v28, v28
    v_exp_f32 v29, v29
    v_exp_f32 v30, v30
    v_smfmac_f32_32x32x32_bf16 v[60:75], v[120:123], v[20:27], v52
    v_exp_f32 v31, v31
    v_exp_f32 v32, v32
    v_exp_f32 v33, v33
    v_exp_f32 v34, v34
    v_exp_f32 v35, v35
    v_exp_f32 v36, v36
    v_exp_f32 v37, v37
    v_smfmac_f32_32x32x32_bf16 v[60:75], v[124:127], v[28:35], v52
    v_exp_f32 v38, v38
    v_exp_f32 v39, v39
    v_exp_f32 v40, v40
    v_mfma_f32_32x32x16_bf16 v[20:35], v[116:119], v[232:235], 0
    v_exp_f32 v41, v41
    v_exp_f32 v42, v42
    v_exp_f32 v43, v43
    v_exp_f32 v44, v44
    v_exp_f32 v45, v45
    v_exp_f32 v46, v46
    v_smfmac_f32_32x32x32_bf16 v[76:91], v[120:123], v[36:43], v52
    v_exp_f32 v47, v47
    v_exp_f32 v48, v48
    v_exp_f32 v49, v49
    v_exp_f32 v50, v50
    v_exp_f32 v51, v51
    v_exp_f32 v20, v20
    v_exp_f32 v21, v21
    v_smfmac_f32_32x32x32_bf16 v[76:91], v[124:127], v[44:51], v52
    v_exp_f32 v22, v22
    v_exp_f32 v23, v23
    v_exp_f32 v24, v24
    v_mfma_f32_32x32x16_bf16 v[36:51], v[116:119], v[236:239], 0
    v_exp_f32 v25, v25
    v_exp_f32 v26, v26
    v_exp_f32 v27, v27
    v_exp_f32 v28, v28
    v_exp_f32 v29, v29
    v_exp_f32 v30, v30
    v_smfmac_f32_32x32x32_bf16 v[200:215], v[120:123], v[20:27], v52
    v_exp_f32 v31, v31
    v_exp_f32 v32, v32
    v_exp_f32 v33, v33
    v_exp_f32 v34, v34
    v_exp_f32 v35, v35
    v_exp_f32 v36, v36
    v_exp_f32 v37, v37
    v_smfmac_f32_32x32x32_bf16 v[200:215], v[124:127], v[28:35], v52
    s_waitcnt vmcnt(9)
    v_exp_f32 v38, v38
    v_exp_f32 v39, v39
    v_exp_f32 v40, v40
    v_mfma_f32_32x32x16_bf16 v[20:35], v[128:131], v[8:11], 0
    v_exp_f32 v41, v41
    v_exp_f32 v42, v42
    v_exp_f32 v43, v43
    v_exp_f32 v44, v44
    v_exp_f32 v45, v45
    v_exp_f32 v46, v46
    v_smfmac_f32_32x32x32_bf16 v[216:231], v[120:123], v[36:43], v52
    v_exp_f32 v47, v47
    v_exp_f32 v48, v48
    v_exp_f32 v49, v49
    v_exp_f32 v50, v50
    v_exp_f32 v51, v51
    v_exp_f32 v20, v20
    v_exp_f32 v21, v21
    v_smfmac_f32_32x32x32_bf16 v[216:231], v[124:127], v[44:51], v52
    v_exp_f32 v22, v22
    v_exp_f32 v23, v23
    v_exp_f32 v24, v24
    v_mfma_f32_32x32x16_bf16 v[36:51], v[128:131], v[12:15], 0
    v_exp_f32 v25, v25
    v_exp_f32 v26, v26
    v_exp_f32 v27, v27
    v_exp_f32 v28, v28
    v_exp_f32 v29, v29
    v_exp_f32 v30, v30
    v_smfmac_f32_32x32x32_bf16 v[60:75], v[132:135], v[20:27], v52
    v_exp_f32 v31, v31
    v_exp_f32 v32, v32
    v_exp_f32 v33, v33
    v_exp_f32 v34, v34
    v_exp_f32 v35, v35
    v_exp_f32 v36, v36
    v_exp_f32 v37, v37
    v_smfmac_f32_32x32x32_bf16 v[60:75], v[136:139], v[28:35], v52
    v_exp_f32 v38, v38
    v_exp_f32 v39, v39
    v_exp_f32 v40, v40
    v_mfma_f32_32x32x16_bf16 v[20:35], v[128:131], v[232:235], 0
    v_exp_f32 v41, v41
    v_exp_f32 v42, v42
    v_exp_f32 v43, v43
    v_exp_f32 v44, v44
    v_exp_f32 v45, v45
    v_exp_f32 v46, v46
    v_smfmac_f32_32x32x32_bf16 v[76:91], v[132:135], v[36:43], v52
    v_exp_f32 v47, v47
    v_exp_f32 v48, v48
    v_exp_f32 v49, v49
    v_exp_f32 v50, v50
    v_exp_f32 v51, v51
    v_exp_f32 v20, v20
    v_exp_f32 v21, v21
    v_smfmac_f32_32x32x32_bf16 v[76:91], v[136:139], v[44:51], v52
    v_exp_f32 v22, v22
    v_exp_f32 v23, v23
    v_exp_f32 v24, v24
    v_mfma_f32_32x32x16_bf16 v[36:51], v[128:131], v[236:239], 0
    v_exp_f32 v25, v25
    v_exp_f32 v26, v26
    v_exp_f32 v27, v27
    v_exp_f32 v28, v28
    v_exp_f32 v29, v29
    v_exp_f32 v30, v30
    v_smfmac_f32_32x32x32_bf16 v[200:215], v[132:135], v[20:27], v52
    v_exp_f32 v31, v31
    v_exp_f32 v32, v32
    v_exp_f32 v33, v33
    v_exp_f32 v34, v34
    v_exp_f32 v35, v35
    v_exp_f32 v36, v36
    v_exp_f32 v37, v37
    v_smfmac_f32_32x32x32_bf16 v[200:215], v[136:139], v[28:35], v52
    s_waitcnt vmcnt(6)
    v_exp_f32 v38, v38
    v_exp_f32 v39, v39
    v_exp_f32 v40, v40
    v_mfma_f32_32x32x16_bf16 v[20:35], v[152:155], v[8:11], 0
    v_exp_f32 v41, v41
    v_exp_f32 v42, v42
    v_exp_f32 v43, v43
    v_exp_f32 v44, v44
    v_exp_f32 v45, v45
    v_exp_f32 v46, v46
    v_smfmac_f32_32x32x32_bf16 v[216:231], v[132:135], v[36:43], v52
    v_exp_f32 v47, v47
    v_exp_f32 v48, v48
    v_exp_f32 v49, v49
    v_exp_f32 v50, v50
    v_exp_f32 v51, v51
    s_nop 1
    v_smfmac_f32_32x32x32_bf16 v[216:231], v[136:139], v[44:51], v52
    v_mov_b32 v250, 163776
    s_mov_b32 s59, 2097152
L_lw_17:
    ds_read_b32 v251, v250 offset:40
    s_waitcnt lgkmcnt(0)
    v_cmp_gt_u32 vcc, 4, v251
    s_cbranch_vccz L_lw_17_ok
    s_sleep 1
    s_sub_u32 s59, s59, 1
    s_cmp_lg_u32 s59, 0
    s_cbranch_scc1 L_lw_17
L_lw_17_ok:
    s_add_u32 m0, s39, s15
    s_add_u32 s15, s15, 2048
    buffer_load_dwordx4 v7, s[8:11], s38 offen lds
    s_add_u32 m0, m0, 16384
    s_nop 0
    buffer_load_dwordx4 v4, s[8:11], s38 offen lds
    s_add_u32 s38, s38, 16384
    s_and_b32 s38, s38, 0x1ffff
    v_mov_b32 v44, 0
    v_mov_b32 v45, 0
    v_mov_b32 v46, 0
    v_mov_b32 v47, 0
    v_mov_b32 v48, 0
    v_mov_b32 v49, 0
    v_mov_b32 v50, 0
    v_mov_b32 v51, 0
    s_branch L_A_loop
L_p2_late:
    s_waitcnt vmcnt(0)
    v_mov_b32 v250, 163776
    v_mov_b32 v251, 1
    s_mov_b64 exec, 1
    ds_add_rtn_u32 v251, v250, v251 offset:8
    s_lshl_b32 s60, s55, 5
    s_add_u32 s60, s60, s3
    s_lshl_b32 s60, s60, 7
    s_add_u32 s60, s60, 17072128
    s_waitcnt lgkmcnt(0)
    v_readfirstlane_b32 s59, v251
    s_mov_b64 exec, 0xff
    v_mov_b32 v252, s30
    v_mov_b32 v253, s31
    v_mov_b32 v254, s30
    v_mov_b32 v255, s31
    s_cmp_lg_u32 s59, 3
    s_cbranch_scc1 L_pub_18
    buffer_store_dwordx4 v[252:255], v2, s[16:19], s60 offen sc1
L_pub_18:
    s_mov_b64 exec, -1
    v_mov_b32 v250, 163776
    s_mov_b32 s59, 2097152
L_lw_19:
    ds_read_b32 v251, v250 offset:40
    s_waitcnt lgkmcnt(0)
    v_cmp_gt_u32 vcc, 4, v251
    s_cbranch_vccz L_lw_19_ok
    s_sleep 1
    s_sub_u32 s59, s59, 1
    s_cmp_lg_u32 s59, 0
    s_cbranch_scc1 L_lw_19
L_lw_19_ok:
    s_lshl_b32 s60, s33, 7
    s_add_u32 s60, s60, 154624
    v_add_u32 v148, s60, v6
    ds_read_b32 v53, v148
    ds_read_b32 v54, v148 offset:128
    s_lshl_b32 s60, s13, 12
    s_add_u32 s60, s60, 131072
    s_lshl_b32 s61, s33, 10
    s_add_u32 s61, s61, s60
    v_add_u32 v151, s61, v2
    v_xor_b32 v5, 2048, v151
    ds_read_b128 v[8:11], v151 offset:0
    ds_read_b128 v[12:15], v151 offset:1024
    ds_read_b128 v[232:235], v5 offset:0
    ds_read_b128 v[236:239], v5 offset:1024
    ds_read_b128 v[16:19], v151 offset:8192
    ds_read_b128 v[240:243], v151 offset:9216
    s_waitcnt lgkmcnt(0)
    v_mov_b32 v250, 163776
    v_mov_b32 v251, 1
    s_mov_b64 exec, 1
    ds_add_u32 v250, v251 offset:60
    s_mov_b64 exec, -1
    s_and_b32 s61, s3, 30
    s_sub_i32 s61, s61, 4
    s_max_i32 s61, s61, 0
    s_or_b32 s62, s3, 1
    s_cmp_lg_u32 s52, 0
    s_cbranch_scc1 L_ps_20_w
    s_lshl_b32 s60, s55, 12
    s_add_u32 s60, s60, 17072128
    v_and_b32 v250, 31, v1
    v_max_u32 v250, s61, v250
    v_min_u32 v250, s62, v250
    v_lshlrev_b32 v250, 7, v250
    s_mov_b32 s59, 262144
L_poll_21:
    buffer_load_dwordx2 v[252:253], v250, s[16:19], s60 offen sc1
    s_waitcnt vmcnt(0)
    v_cmp_ne_u64 vcc, s[30:31], v[252:253]
    s_cbranch_vccz L_poll_21_ok
    s_sleep 2
    s_sub_u32 s59, s59, 1
    s_cmp_lg_u32 s59, 0
    s_cbranch_scc1 L_poll_21
L_poll_21_ok:
    v_mov_b32 v250, 163776
    v_mov_b32 v251, 1
    s_mov_b64 exec, 1
    ds_add_u32 v250, v251 offset:4
    s_mov_b64 exec, -1
    s_branch L_ps_20_d
L_ps_20_w:
    v_mov_b32 v250, 163776
    s_mov_b32 s59, 2097152
L_lw_22:
    ds_read_b32 v251, v250 offset:4
    s_waitcnt lgkmcnt(0)
    v_cmp_gt_u32 vcc, 5, v251
    s_cbranch_vccz L_lw_22_ok
    s_sleep 1
    s_sub_u32 s59, s59, 1
    s_cmp_lg_u32 s59, 0
    s_cbranch_scc1 L_lw_22
L_lw_22_ok:
L_ps_20_d:
    s_add_u32 s34, s57, 1
    s_lshl_b32 s34, s34, 11
    buffer_load_dwordx4 v[152:155], v149, s[16:19], s34 offen offset:0 sc1
    buffer_load_dwordx4 v[156:159], v150, s[16:19], s34 offen offset:1024 sc1
    buffer_load_dwordx4 v[160:163], v150, s[16:19], s34 offen offset:1536 sc1
    s_sub_i32 s34, s34, 2048
    s_max_i32 s34, s34, 0
    buffer_load_dwordx4 v[164:167], v149, s[16:19], s34 offen offset:0 sc1
    buffer_load_dwordx4 v[168:171], v150, s[16:19], s34 offen offset:1024 sc1
    buffer_load_dwordx4 v[172:175], v150, s[16:19], s34 offen offset:1536 sc1
    s_sub_i32 s34, s34, 2048
    s_max_i32 s34, s34, 0
    buffer_load_dwordx4 v[176:179], v149, s[16:19], s34 offen offset:0 sc1
    buffer_load_dwordx4 v[180:183], v150, s[16:19], s34 offen offset:1024 sc1
    buffer_load_dwordx4 v[184:187], v150, s[16:19], s34 offen offset:1536 sc1
    s_sub_i32 s34, s34, 2048
    s_max_i32 s34, s34, 0
    buffer_load_dwordx4 v[188:191], v149, s[16:19], s34 offen offset:0 sc1
    buffer_load_dwordx4 v[192:195], v150, s[16:19], s34 offen offset:1024 sc1
    buffer_load_dwordx4 v[196:199], v150, s[16:19], s34 offen offset:1536 sc1
    s_sub_i32 s34, s34, 2048
    s_max_i32 s34, s34, 0
    v_mov_b32 v250, 163776
    s_mov_b32 s59, 2097152
L_lw_23:
    ds_read_b32 v251, v250 offset:36
    s_waitcnt lgkmcnt(0)
    v_cmp_gt_u32 vcc, 1, v251
    s_cbranch_vccz L_lw_23_ok
    s_sleep 1
    s_sub_u32 s59, s59, 1
    s_cmp_lg_u32 s59, 0
    s_cbranch_scc1 L_lw_23
L_lw_23_ok:
    s_waitcnt vmcnt(9)
    v_mfma_f32_32x32x16_bf16 v[20:35], v[152:155], v[240:243], v[108:123]
    s_nop 11
    v_exp_f32 v20, v20
    v_exp_f32 v21, v21
    s_waitcnt vmcnt(6)
    v_exp_f32 v22, v22
    v_exp_f32 v23, v23
    v_exp_f32 v24, v24
    v_mfma_f32_32x32x16_bf16 v[36:51], v[164:167], v[16:19], v[108:123]
    v_exp_f32 v25, v25
    v_exp_f32 v26, v26
    v_exp_f32 v27, v27
    v_exp_f32 v28, v28
    v_exp_f32 v29, v29
    v_exp_f32 v30, v30
    v_smfmac_f32_32x32x32_bf16 v[76:91], v[156:159], v[20:27], v52
    v_exp_f32 v31, v31
    v_exp_f32 v32, v32
    v_exp_f32 v33, v33
    v_exp_f32 v34, v34
    v_exp_f32 v35, v35
    v_exp_f32 v36, v36
    v_exp_f32 v37, v37
    v_smfmac_f32_32x32x32_bf16 v[76:91], v[160:163], v[28:35], v52
    buffer_load_dwordx4 v[152:155], v149, s[16:19], s34 offen offset:0 sc1
    v_exp_f32 v38, v38
    v_exp_f32 v39, v39
    v_exp_f32 v40, v40
    v_mfma_f32_32x32x16_bf16 v[20:35], v[164:167], v[240:243], 0
    buffer_load_dwordx4 v[156:159], v150, s[16:19], s34 offen offset:1024 sc1
    v_exp_f32 v41, v41
    v_exp_f32 v42, v42
    v_exp_f32 v43, v43
    v_exp_f32 v44, v44
    v_exp_f32 v45, v45
    v_exp_f32 v46, v46
    v_smfmac_f32_32x32x32_bf16 v[60:75], v[168:171], v[36:43], v52
    buffer_load_dwordx4 v[160:163], v150, s[16:19], s34 offen offset:1536 sc1
    s_sub_i32 s34, s34, 2048
    s_max_i32 s34, s34, 0
    v_exp_f32 v47, v47
    v_exp_f32 v48, v48
    v_exp_f32 v49, v49
    v_exp_f32 v50, v50
    v_exp_f32 v51, v51
    v_exp_f32 v20, v20
    v_exp_f32 v21, v21
    v_smfmac_f32_32x32x32_bf16 v[60:75], v[172:175], v[44:51], v52
    s_waitcnt vmcnt(6)
    s_cmp_lt_u32 s57, 1
    v_exp_f32 v22, v22
    v_exp_f32 v23, v23
    v_exp_f32 v24, v24
    s_cbranch_scc1 L_bmask_24
    v_mfma_f32_32x32x16_bf16 v[36:51], v[176:179], v[16:19], 0
L_bmask_24_r:
    v_exp_f32 v25, v25
    v_exp_f32 v26, v26
    v_exp_f32 v27, v27
    v_exp_f32 v28, v28
    v_exp_f32 v29, v29
    v_exp_f32 v30, v30
    v_smfmac_f32_32x32x32_bf16 v[76:91], v[168:171], v[20:27], v52
    v_exp_f32 v31, v31
    v_exp_f32 v32, v32
    v_exp_f32 v33, v33
    v_exp_f32 v34, v34
    v_exp_f32 v35, v35
    v_exp_f32 v36, v36
    v_exp_f32 v37, v37
    v_smfmac_f32_32x32x32_bf16 v[76:91], v[172:175], v[28:35], v52
    buffer_load_dwordx4 v[164:167], v149, s[16:19], s34 offen offset:0 sc1
    s_cmp_lt_u32 s57, 1
    v_exp_f32 v38, v38
    v_exp_f32 v39, v39
    v_exp_f32 v40, v40
    s_cbranch_scc1 L_bmask_25
    v_mfma_f32_32x32x16_bf16 v[20:35], v[176:179], v[240:243], 0
L_bmask_25_r:
    buffer_load_dwordx4 v[168:171], v150, s[16:19], s34 offen offset:1024 sc1
    v_exp_f32 v41, v41
    v_exp_f32 v42, v42
    v_exp_f32 v43, v43
    v_exp_f32 v44, v44
    v_exp_f32 v45, v45
    v_exp_f32 v46, v46
    v_smfmac_f32_32x32x32_bf16 v[60:75], v[180:183], v[36:43], v52
    buffer_load_dwordx4 v[172:175], v150, s[16:19], s34 offen offset:1536 sc1
    s_sub_i32 s34, s34, 2048
    s_max_i32 s34, s34, 0
    v_exp_f32 v47, v47
    v_exp_f32 v48, v48
    v_exp_f32 v49, v49
    v_exp_f32 v50, v50
    v_exp_f32 v51, v51
    v_exp_f32 v20, v20
    v_exp_f32 v21, v21
    v_smfmac_f32_32x32x32_bf16 v[60:75], v[184:187], v[44:51], v52
    s_waitcnt vmcnt(6)
    s_cmp_lt_u32 s57, 2
    v_exp_f32 v22, v22
    v_exp_f32 v23, v23
    v_exp_f32 v24, v24
    s_cbranch_scc1 L_bmask_26
    v_mfma_f32_32x32x16_bf16 v[36:51], v[188:191], v[16:19], 0
L_bmask_26_r:
    v_exp_f32 v25, v25
    v_exp_f32 v26, v26
    v_exp_f32 v27, v27
    v_exp_f32 v28, v28
    v_exp_f32 v29, v29
    v_exp_f32 v30, v30
    v_smfmac_f32_32x32x32_bf16 v[76:91], v[180:183], v[20:27], v52
    v_exp_f32 v31, v31
    v_exp_f32 v32, v32
    v_exp_f32 v33, v33
    v_exp_f32 v34, v34
    v_exp_f32 v35, v35
    v_exp_f32 v36, v36
    v_exp_f32 v37, v37
    v_smfmac_f32_32x32x32_bf16 v[76:91], v[184:187], v[28:35], v52
    buffer_load_dwordx4 v[176:179], v149, s[16:19], s34 offen offset:0 sc1
    s_cmp_lt_u32 s57, 2
    v_exp_f32 v38, v38
    v_exp_f32 v39, v39
    v_exp_f32 v40, v40
    s_cbranch_scc1 L_bmask_27
    v_mfma_f32_32x32x16_bf16 v[20:35], v[188:191], v[240:243], 0
L_bmask_27_r:
    buffer_load_dwordx4 v[180:183], v150, s[16:19], s34 offen offset:1024 sc1
    v_exp_f32 v41, v41
    v_exp_f32 v42, v42
    v_exp_f32 v43, v43
    v_exp_f32 v44, v44
    v_exp_f32 v45, v45
    v_exp_f32 v46, v46
    v_smfmac_f32_32x32x32_bf16 v[60:75], v[192:195], v[36:43], v52
    buffer_load_dwordx4 v[184:187], v150, s[16:19], s34 offen offset:1536 sc1
    s_sub_i32 s34, s34, 2048
    s_max_i32 s34, s34, 0
    v_exp_f32 v47, v47
    v_exp_f32 v48, v48
    v_exp_f32 v49, v49
    v_exp_f32 v50, v50
    v_exp_f32 v51, v51
    v_exp_f32 v20, v20
    v_exp_f32 v21, v21
    v_smfmac_f32_32x32x32_bf16 v[60:75], v[196:199], v[44:51], v52
    s_waitcnt vmcnt(6)
    s_cmp_lt_u32 s57, 3
    v_exp_f32 v22, v22
    v_exp_f32 v23, v23
    v_exp_f32 v24, v24
    s_cbranch_scc1 L_bmask_28
    v_mfma_f32_32x32x16_bf16 v[36:51], v[152:155], v[16:19], 0
L_bmask_28_r:
    v_exp_f32 v25, v25
    v_exp_f32 v26, v26
    v_exp_f32 v27, v27
    v_exp_f32 v28, v28
    v_exp_f32 v29, v29
    v_exp_f32 v30, v30
    v_smfmac_f32_32x32x32_bf16 v[76:91], v[192:195], v[20:27], v52
    v_exp_f32 v31, v31
    v_exp_f32 v32, v32
    v_exp_f32 v33, v33
    v_exp_f32 v34, v34
    v_exp_f32 v35, v35
    v_exp_f32 v36, v36
    v_exp_f32 v37, v37
    v_smfmac_f32_32x32x32_bf16 v[76:91], v[196:199], v[28:35], v52
    buffer_load_dwordx4 v[188:191], v149, s[16:19], s34 offen offset:0 sc1
    s_cmp_lt_u32 s57, 3
    v_exp_f32 v38, v38
    v_exp_f32 v39, v39
    v_exp_f32 v40, v40
    s_cbranch_scc1 L_bmask_29
    v_mfma_f32_32x32x16_bf16 v[20:35], v[152:155], v[240:243], 0
L_bmask_29_r:
    buffer_load_dwordx4 v[192:195], v150, s[16:19], s34 offen offset:1024 sc1
    v_exp_f32 v41, v41
    v_exp_f32 v42, v42
    v_exp_f32 v43, v43
    v_exp_f32 v44, v44
    v_exp_f32 v45, v45
    v_exp_f32 v46, v46
    v_smfmac_f32_32x32x32_bf16 v[60:75], v[156:159], v[36:43], v52
    buffer_load_dwordx4 v[196:199], v150, s[16:19], s34 offen offset:1536 sc1
    s_sub_i32 s34, s34, 2048
    s_max_i32 s34, s34, 0
    v_exp_f32 v47, v47
    v_exp_f32 v48, v48
    v_exp_f32 v49, v49
    v_exp_f32 v50, v50
    v_exp_f32 v51, v51
    v_exp_f32 v20, v20
    v_exp_f32 v21, v21
    v_smfmac_f32_32x32x32_bf16 v[60:75], v[160:163], v[44:51], v52
    s_waitcnt vmcnt(6)
    s_cmp_lt_u32 s57, 4
    v_exp_f32 v22, v22
    v_exp_f32 v23, v23
    v_exp_f32 v24, v24
    s_cbranch_scc1 L_bmask_30
    v_mfma_f32_32x32x16_bf16 v[36:51], v[164:167], v[16:19], 0
L_bmask_30_r:
    v_exp_f32 v25, v25
    v_exp_f32 v26, v26
    v_exp_f32 v27, v27
    v_exp_f32 v28, v28
    v_exp_f32 v29, v29
    v_exp_f32 v30, v30
    v_smfmac_f32_32x32x32_bf16 v[76:91], v[156:159], v[20:27], v52
    v_exp_f32 v31, v31
    v_exp_f32 v32, v32
    v_exp_f32 v33, v33
    v_exp_f32 v34, v34
    v_exp_f32 v35, v35
    v_exp_f32 v36, v36
    v_exp_f32 v37, v37
    v_smfmac_f32_32x32x32_bf16 v[76:91], v[160:163], v[28:35], v52
    buffer_load_dwordx4 v[152:155], v149, s[16:19], s34 offen offset:0 sc1
    s_cmp_lt_u32 s57, 4
    v_exp_f32 v38, v38
    v_exp_f32 v39, v39
    v_exp_f32 v40, v40
    s_cbranch_scc1 L_bmask_31
    v_mfma_f32_32x32x16_bf16 v[20:35], v[164:167], v[240:243], 0
L_bmask_31_r:
    buffer_load_dwordx4 v[156:159], v150, s[16:19], s34 offen offset:1024 sc1
    v_exp_f32 v41, v41
    v_exp_f32 v42, v42
    v_exp_f32 v43, v43
    v_exp_f32 v44, v44
    v_exp_f32 v45, v45
    v_exp_f32 v46, v46
    v_smfmac_f32_32x32x32_bf16 v[60:75], v[168:171], v[36:43], v52
    buffer_load_dwordx4 v[160:163], v150, s[16:19], s34 offen offset:1536 sc1
    s_sub_i32 s34, s34, 2048
    s_max_i32 s34, s34, 0
    v_exp_f32 v47, v47
    v_exp_f32 v48, v48
    v_exp_f32 v49, v49
    v_exp_f32 v50, v50
    v_exp_f32 v51, v51
    v_exp_f32 v20, v20
    v_exp_f32 v21, v21
    v_smfmac_f32_32x32x32_bf16 v[60:75], v[172:175], v[44:51], v52
    s_waitcnt vmcnt(6)
    s_cmp_lt_u32 s57, 5
    v_exp_f32 v22, v22
    v_exp_f32 v23, v23
    v_exp_f32 v24, v24
    s_cbranch_scc1 L_bmask_32
    v_mfma_f32_32x32x16_bf16 v[36:51], v[176:179], v[16:19], 0
L_bmask_32_r:
    v_exp_f32 v25, v25
    v_exp_f32 v26, v26
    v_exp_f32 v27, v27
    v_exp_f32 v28, v28
    v_exp_f32 v29, v29
    v_exp_f32 v30, v30
    v_smfmac_f32_32x32x32_bf16 v[76:91], v[168:171], v[20:27], v52
    v_exp_f32 v31, v31
    v_exp_f32 v32, v32
    v_exp_f32 v33, v33
    v_exp_f32 v34, v34
    v_exp_f32 v35, v35
    v_exp_f32 v36, v36
    v_exp_f32 v37, v37
    v_smfmac_f32_32x32x32_bf16 v[76:91], v[172:175], v[28:35], v52
    buffer_load_dwordx4 v[164:167], v149, s[16:19], s34 offen offset:0 sc1
    s_cmp_lt_u32 s57, 5
    v_exp_f32 v38, v38
    v_exp_f32 v39, v39
    v_exp_f32 v40, v40
    s_cbranch_scc1 L_bmask_33
    v_mfma_f32_32x32x16_bf16 v[20:35], v[176:179], v[240:243], 0
L_bmask_33_r:
    buffer_load_dwordx4 v[168:171], v150, s[16:19], s34 offen offset:1024 sc1
    v_exp_f32 v41, v41
    v_exp_f32 v42, v42
    v_exp_f32 v43, v43
    v_exp_f32 v44, v44
    v_exp_f32 v45, v45
    v_exp_f32 v46, v46
    v_smfmac_f32_32x32x32_bf16 v[60:75], v[180:183], v[36:43], v52
    buffer_load_dwordx4 v[172:175], v150, s[16:19], s34 offen offset:1536 sc1
    s_sub_i32 s34, s34, 2048
    s_max_i32 s34, s34, 0
    v_exp_f32 v47, v47
    v_exp_f32 v48, v48
    v_exp_f32 v49, v49
    v_exp_f32 v50, v50
    v_exp_f32 v51, v51
    v_exp_f32 v20, v20
    v_exp_f32 v21, v21
    v_smfmac_f32_32x32x32_bf16 v[60:75], v[184:187], v[44:51], v52
    s_waitcnt vmcnt(6)
    s_cmp_lt_u32 s57, 6
    v_exp_f32 v22, v22
    v_exp_f32 v23, v23
    v_exp_f32 v24, v24
    s_cbranch_scc1 L_bmask_34
    v_mfma_f32_32x32x16_bf16 v[36:51], v[188:191], v[16:19], 0
L_bmask_34_r:
    v_exp_f32 v25, v25
    v_exp_f32 v26, v26
    v_exp_f32 v27, v27
    v_exp_f32 v28, v28
    v_exp_f32 v29, v29
    v_exp_f32 v30, v30
    v_smfmac_f32_32x32x32_bf16 v[76:91], v[180:183], v[20:27], v52
    v_exp_f32 v31, v31
    v_exp_f32 v32, v32
    v_exp_f32 v33, v33
    v_exp_f32 v34, v34
    v_exp_f32 v35, v35
    v_exp_f32 v36, v36
    v_exp_f32 v37, v37
    v_smfmac_f32_32x32x32_bf16 v[76:91], v[184:187], v[28:35], v52
    s_cmp_lt_u32 s57, 6
    v_exp_f32 v38, v38
    v_exp_f32 v39, v39
    v_exp_f32 v40, v40
    s_cbranch_scc1 L_bmask_35
    v_mfma_f32_32x32x16_bf16 v[20:35], v[188:191], v[240:243], 0
L_bmask_35_r:
    v_exp_f32 v41, v41
    v_exp_f32 v42, v42
    v_exp_f32 v43, v43
    v_exp_f32 v44, v44
    v_exp_f32 v45, v45
    v_exp_f32 v46, v46
    v_smfmac_f32_32x32x32_bf16 v[60:75], v[192:195], v[36:43], v52
    v_exp_f32 v47, v47
    v_exp_f32 v48, v48
    v_exp_f32 v49, v49
    v_exp_f32 v50, v50
    v_exp_f32 v51, v51
    v_exp_f32 v20, v20
    v_exp_f32 v21, v21
    v_smfmac_f32_32x32x32_bf16 v[60:75], v[196:199], v[44:51], v52
    s_waitcnt vmcnt(3)
    s_cmp_lt_u32 s57, 7
    v_exp_f32 v22, v22
    v_exp_f32 v23, v23
    v_exp_f32 v24, v24
    s_cbranch_scc1 L_bmask_36
    v_mfma_f32_32x32x16_bf16 v[36:51], v[152:155], v[16:19], 0
L_bmask_36_r:
    v_exp_f32 v25, v25
    v_exp_f32 v26, v26
    v_exp_f32 v27, v27
    v_exp_f32 v28, v28
    v_exp_f32 v29, v29
    v_exp_f32 v30, v30
    v_smfmac_f32_32x32x32_bf16 v[76:91], v[192:195], v[20:27], v52
    v_exp_f32 v31, v31
    v_exp_f32 v32, v32
    v_exp_f32 v33, v33
    v_exp_f32 v34, v34
    v_exp_f32 v35, v35
    v_exp_f32 v36, v36
    v_exp_f32 v37, v37
    v_smfmac_f32_32x32x32_bf16 v[76:91], v[196:199], v[28:35], v52
    v_exp_f32 v38, v38
    v_exp_f32 v39, v39
    v_exp_f32 v40, v40
    v_mfma_f32_32x32x16_bf16 v[20:35], v[152:155], v[240:243], v[124:139]
    v_exp_f32 v41, v41
    v_exp_f32 v42, v42
    v_exp_f32 v43, v43
    v_exp_f32 v44, v44
    v_exp_f32 v45, v45
    v_exp_f32 v46, v46
    v_smfmac_f32_32x32x32_bf16 v[60:75], v[156:159], v[36:43], v52
    v_exp_f32 v47, v47
    v_exp_f32 v48, v48
    v_exp_f32 v49, v49
    v_exp_f32 v50, v50
    v_exp_f32 v51, v51
    v_exp_f32 v20, v20
    v_exp_f32 v21, v21
    v_smfmac_f32_32x32x32_bf16 v[60:75], v[160:163], v[44:51], v52
    s_waitcnt vmcnt(0)
    v_exp_f32 v22, v22
    v_exp_f32 v23, v23
    v_exp_f32 v24, v24
    v_mfma_f32_32x32x16_bf16 v[36:51], v[164:167], v[16:19], v[124:139]
    v_exp_f32 v25, v25
    v_exp_f32 v26, v26
    v_exp_f32 v27, v27
    v_exp_f32 v28, v28
    v_exp_f32 v29, v29
    v_exp_f32 v30, v30
    v_smfmac_f32_32x32x32_bf16 v[76:91], v[156:159], v[20:27], v52
    s_add_u32 m0, s39, s15
    s_add_u32 s15, s15, 2048
    buffer_load_dwordx4 v7, s[8:11], s38 offen lds
    s_add_u32 m0, m0, 16384
    s_nop 0
    buffer_load_dwordx4 v4, s[8:11], s38 offen lds
    s_add_u32 s38, s38, 16384
    s_and_b32 s38, s38, 0x1ffff
    v_exp_f32 v31, v31
    v_exp_f32 v32, v32
    v_exp_f32 v33, v33
    v_exp_f32 v34, v34
    v_exp_f32 v35, v35
    v_exp_f32 v36, v36
    v_exp_f32 v37, v37
    v_smfmac_f32_32x32x32_bf16 v[76:91], v[160:163], v[28:35], v52
    v_exp_f32 v38, v38
    v_exp_f32 v39, v39
    v_exp_f32 v40, v40
    v_exp_f32 v41, v41
    v_exp_f32 v42, v42
    v_exp_f32 v43, v43
    v_exp_f32 v44, v44
    v_exp_f32 v45, v45
    v_exp_f32 v46, v46
    v_smfmac_f32_32x32x32_bf16 v[60:75], v[168:171], v[36:43], v52
    v_exp_f32 v47, v47
    v_exp_f32 v48, v48
    v_exp_f32 v49, v49
    v_exp_f32 v50, v50
    v_exp_f32 v51, v51
    s_nop 1
    v_smfmac_f32_32x32x32_bf16 v[60:75], v[172:175], v[44:51], v52
    buffer_load_dwordx4 v[152:155], v144, s[16:19], s66 offen offset:0 sc1
    buffer_load_dwordx4 v[156:159], v145, s[16:19], s66 offen offset:1024 sc1
    buffer_load_dwordx4 v[160:163], v145, s[16:19], s66 offen offset:1536 sc1
    buffer_load_dwordx4 v[164:167], v144, s[16:19], s66 offen offset:2048 sc1
    buffer_load_dwordx4 v[168:171], v145, s[16:19], s66 offen offset:3072 sc1
    buffer_load_dwordx4 v[172:175], v145, s[16:19], s66 offen offset:3584 sc1
    s_add_u32 s66, s66, 4096
    s_and_b32 s66, s66, 0x1ffff
    buffer_load_dwordx4 v[176:179], v144, s[16:19], s66 offen offset:0 sc1
    buffer_load_dwordx4 v[180:183], v145, s[16:19], s66 offen offset:1024 sc1
    buffer_load_dwordx4 v[184:187], v145, s[16:19], s66 offen offset:1536 sc1
    v_mov_b32 v252, -1
    v_mov_b32 v253, -1
    v_mov_b32 v254, -1
    v_mov_b32 v255, -1
    s_add_u32 s60, s64, 12582912
    buffer_store_dwordx4 v[252:255], v2, s[16:19], s60 offen sc1
    buffer_store_dwordx4 v[252:255], v2, s[16:19], s60 offen offset:1024 sc1
    v_sub_f32 v142, 1.0, v53
    v_sub_f32 v143, 1.0, v54
    s_add_u32 s40, s64, 14680064
    s_add_u32 s41, s40, 1024
    s_add_u32 s58, s57, 1
L_B1_fin:
    v_rcp_f32 v151, v84
    v_cmp_gt_f32 s[60:61], s26, v84
    v_cmp_lt_f32 vcc, 0x1f800000, v84
    v_mul_f32 v151, v143, v151
    v_mul_f32 v76, v151, v76
    v_mul_f32 v77, v151, v77
    v_mul_f32 v78, v151, v78
    v_mul_f32 v79, v151, v79
    v_mul_f32 v80, v151, v80
    v_mul_f32 v81, v151, v81
    v_mul_f32 v82, v151, v82
    v_mul_f32 v83, v151, v83
    v_add_f32 v5, |v76|, |v77|
    v_add_f32 v5, v5, |v78|
    v_add_f32 v5, v5, |v79|
    v_add_f32 v5, v5, |v80|
    v_add_f32 v5, v5, |v81|
    v_add_f32 v5, v5, |v82|
    v_add_f32 v5, v5, |v83|
    v_cmp_gt_f32 s[62:63], s27, v5
    v_cvt_pk_bf16_f32 v88, v76, v77
    v_cvt_pk_bf16_f32 v89, v78, v79
    v_cvt_pk_bf16_f32 v90, v80, v81
    v_cvt_pk_bf16_f32 v91, v82, v83
    s_and_b64 s[60:61], s[60:61], vcc
    s_and_b64 s[60:61], s[60:61], s[62:63]
    s_cmp_eq_u64 s[60:61], -1
    s_cselect_b32 s60, 1, s29
    s_cmp_eq_u32 s60, 0
    s_cbranch_scc1 L_B1_fb
    buffer_store_dwordx4 v[88:91], v2, s[16:19], s41 offen sc1
    s_mov_b32 s58, s57
L_B0_fin:
    v_rcp_f32 v151, v68
    v_cmp_gt_f32 s[60:61], s26, v68
    v_cmp_lt_f32 vcc, 0x1f800000, v68
    v_mul_f32 v151, v142, v151
    v_mul_f32 v60, v151, v60
    v_mul_f32 v61, v151, v61
    v_mul_f32 v62, v151, v62
    v_mul_f32 v63, v151, v63
    v_mul_f32 v64, v151, v64
    v_mul_f32 v65, v151, v65
    v_mul_f32 v66, v151, v66
    v_mul_f32 v67, v151, v67
    v_add_f32 v5, |v60|, |v61|
    v_add_f32 v5, v5, |v62|
    v_add_f32 v5, v5, |v63|
    v_add_f32 v5, v5, |v64|
    v_add_f32 v5, v5, |v65|
    v_add_f32 v5, v5, |v66|
    v_add_f32 v5, v5, |v67|
    v_cmp_gt_f32 s[62:63], s27, v5
    v_cvt_pk_bf16_f32 v72, v60, v61
    v_cvt_pk_bf16_f32 v73, v62, v63
    v_cvt_pk_bf16_f32 v74, v64, v65
    v_cvt_pk_bf16_f32 v75, v66, v67
    s_and_b64 s[60:61], s[60:61], vcc
    s_and_b64 s[60:61], s[60:61], s[62:63]
    s_cmp_eq_u64 s[60:61], -1
    s_cselect_b32 s60, 1, s28
    s_cmp_eq_u32 s60, 0
    s_cbranch_scc1 L_B0_fb
    buffer_store_dwordx4 v[72:75], v2, s[16:19], s40 offen sc1
    s_nop 1
    v_mfma_f32_32x32x16_bf16 v[60:75], v[92:95], v[92:95], 0
    v_mfma_f32_32x32x16_bf16 v[76:91], v[92:95], v[92:95], 0
    s_waitcnt vmcnt(6)
L_A_go:
    v_mfma_f32_32x32x16_bf16 v[20:35], v[152:155], v[8:11], 0
    v_mov_b32 v44, 0
    v_mov_b32 v45, 0
    v_mov_b32 v46, 0
    v_mov_b32 v47, 0
    v_mov_b32 v48, 0
    v_mov_b32 v49, 0
    v_mov_b32 v50, 0
    v_mov_b32 v51, 0
    s_nop 3
.p2align 3
L_A_loop:
    v_exp_f32 v20, v20
    v_exp_f32 v21, v21
    v_smfmac_f32_32x32x32_bf16 v[216:231], v[196:199], v[44:51], v52
    buffer_load_dwordx4 v[188:191], v144, s[16:19], s66 offen offset:2048 sc1
    v_exp_f32 v22, v22
    v_exp_f32 v23, v23
    v_exp_f32 v24, v24
    v_mfma_f32_32x32x16_bf16 v[36:51], v[152:155], v[12:15], 0
    buffer_load_dwordx4 v[192:195], v145, s[16:19], s66 offen offset:3072 sc1
    v_exp_f32 v25, v25
    v_exp_f32 v26, v26
    v_exp_f32 v27, v27
    v_exp_f32 v28, v28
    v_exp_f32 v29, v29
    v_exp_f32 v30, v30
    v_smfmac_f32_32x32x32_bf16 v[60:75], v[156:159], v[20:27], v52
    buffer_load_dwordx4 v[196:199], v145, s[16:19], s66 offen offset:3584 sc1
    v_exp_f32 v31, v31
    v_exp_f32 v32, v32
    v_exp_f32 v33, v33
    v_exp_f32 v34, v34
    v_exp_f32 v35, v35
    v_exp_f32 v36, v36
    v_exp_f32 v37, v37
    v_smfmac_f32_32x32x32_bf16 v[60:75], v[160:163], v[28:35], v52
    s_add_u32 m0, s39, s15
    v_exp_f32 v38, v38
    v_exp_f32 v39, v39
    v_exp_f32 v40, v40
    v_mfma_f32_32x32x16_bf16 v[20:35], v[152:155], v[232:235], 0
    buffer_load_dwordx4 v7, s[8:11], s38 offen lds
    v_exp_f32 v41, v41
    v_exp_f32 v42, v42
    v_exp_f32 v43, v43
    v_exp_f32 v44, v44
    v_exp_f32 v45, v45
    v_exp_f32 v46, v46
    v_smfmac_f32_32x32x32_bf16 v[76:91], v[156:159], v[36:43], v52
    s_add_u32 m0, m0, s44
    v_exp_f32 v47, v47
    v_exp_f32 v48, v48
    v_exp_f32 v49, v49
    v_exp_f32 v50, v50
    v_exp_f32 v51, v51
    v_exp_f32 v20, v20
    v_exp_f32 v21, v21
    v_smfmac_f32_32x32x32_bf16 v[76:91], v[160:163], v[44:51], v52
    buffer_load_dwordx4 v4, s[8:11], s38 offen lds
    v_exp_f32 v22, v22
    v_exp_f32 v23, v23
    v_exp_f32 v24, v24
    v_mfma_f32_32x32x16_bf16 v[36:51], v[152:155], v[236:239], 0
    s_add_u32 s38, s38, 16384
    v_exp_f32 v25, v25
    v_exp_f32 v26, v26
    v_exp_f32 v27, v27
    v_exp_f32 v28, v28
    v_exp_f32 v29, v29
    v_exp_f32 v30, v30
    v_smfmac_f32_32x32x32_bf16 v[200:215], v[156:159], v[20:27], v52
    s_and_b32 s38, s38, 0x1ffff
    v_exp_f32 v31, v31
    v_exp_f32 v32, v32
    v_exp_f32 v33, v33
    v_exp_f32 v34, v34
    v_exp_f32 v35, v35
    v_exp_f32 v36, v36
    v_exp_f32 v37, v37
    v_smfmac_f32_32x32x32_bf16 v[200:215], v[160:163], v[28:35], v52
    s_waitcnt vmcnt(6)
    v_exp_f32 v38, v38
    v_exp_f32 v39, v39
    v_exp_f32 v40, v40
    v_mfma_f32_32x32x16_bf16 v[20:35], v[164:167], v[8:11], 0
    s_add_u32 s66, s66, 4096
    v_exp_f32 v41, v41
    v_exp_f32 v42, v42
    v_exp_f32 v43, v43
    v_exp_f32 v44, v44
    v_exp_f32 v45, v45
    v_exp_f32 v46, v46
    v_smfmac_f32_32x32x32_bf16 v[216:231], v[156:159], v[36:43], v52
    s_and_b32 s66, s66, 0x1ffff
    v_exp_f32 v47, v47
    v_exp_f32 v48, v48
    v_exp_f32 v49, v49
    v_exp_f32 v50, v50
    v_exp_f32 v51, v51
    v_exp_f32 v20, v20
    v_exp_f32 v21, v21
    v_smfmac_f32_32x32x32_bf16 v[216:231], v[160:163], v[44:51], v52
    buffer_load_dwordx4 v[152:155], v144, s[16:19], s66 offen offset:0 sc1
    v_exp_f32 v22, v22
    v_exp_f32 v23, v23
    v_exp_f32 v24, v24
    v_mfma_f32_32x32x16_bf16 v[36:51], v[164:167], v[12:15], 0
    buffer_load_dwordx4 v[156:159], v145, s[16:19], s66 offen offset:1024 sc1
    v_exp_f32 v25, v25
    v_exp_f32 v26, v26
    v_exp_f32 v27, v27
    v_exp_f32 v28, v28
    v_exp_f32 v29, v29
    v_exp_f32 v30, v30
    v_smfmac_f32_32x32x32_bf16 v[60:75], v[168:171], v[20:27], v52
    buffer_load_dwordx4 v[160:163], v145, s[16:19], s66 offen offset:1536 sc1
    v_exp_f32 v31, v31
    v_exp_f32 v32, v32
    v_exp_f32 v33, v33
    v_exp_f32 v34, v34
    v_exp_f32 v35, v35
    v_exp_f32 v36, v36
    v_exp_f32 v37, v37
    v_smfmac_f32_32x32x32_bf16 v[60:75], v[172:175], v[28:35], v52
    s_add_u32 s15, s15, 2048
    v_exp_f32 v38, v38
    v_exp_f32 v39, v39
    v_exp_f32 v40, v40
    v_mfma_f32_32x32x16_bf16 v[20:35], v[164:167], v[232:235], 0
    v_exp_f32 v41, v41
    v_exp_f32 v42, v42
    v_exp_f32 v43, v43
    v_exp_f32 v44, v44
    v_exp_f32 v45, v45
    v_exp_f32 v46, v46
    v_smfmac_f32_32x32x32_bf16 v[76:91], v[168:171], v[36:43], v52
    s_and_b32 s15, s15, 0x3fff
    v_exp_f32 v47, v47
    v_exp_f32 v48, v48
    v_exp_f32 v49, v49
    v_exp_f32 v50, v50
    v_exp_f32 v51, v51
    v_exp_f32 v20, v20
    v_exp_f32 v21, v21
    v_smfmac_f32_32x32x32_bf16 v[76:91], v[172:175], v[44:51], v52
    v_exp_f32 v22, v22
    v_exp_f32 v23, v23
    v_exp_f32 v24, v24
    v_mfma_f32_32x32x16_bf16 v[36:51], v[164:167], v[236:239], 0
    v_exp_f32 v25, v25
    v_exp_f32 v26, v26
    v_exp_f32 v27, v27
    v_exp_f32 v28, v28
    v_exp_f32 v29, v29
    v_exp_f32 v30, v30
    v_smfmac_f32_32x32x32_bf16 v[200:215], v[168:171], v[20:27], v52
    v_exp_f32 v31, v31
    v_exp_f32 v32, v32
    v_exp_f32 v33, v33
    v_exp_f32 v34, v34
    v_exp_f32 v35, v35
    v_exp_f32 v36, v36
    v_exp_f32 v37, v37
    v_smfmac_f32_32x32x32_bf16 v[200:215], v[172:175], v[28:35], v52
    s_waitcnt vmcnt(6)
    v_exp_f32 v38, v38
    v_exp_f32 v39, v39
    v_exp_f32 v40, v40
    v_mfma_f32_32x32x16_bf16 v[20:35], v[176:179], v[8:11], 0
    s_sub_u32 s67, s67, 1
    v_exp_f32 v41, v41
    v_exp_f32 v42, v42
    v_exp_f32 v43, v43
    v_exp_f32 v44, v44
    v_exp_f32 v45, v45
    v_exp_f32 v46, v46
    v_smfmac_f32_32x32x32_bf16 v[216:231], v[168:171], v[36:43], v52
    s_cmp_gt_i32 s67, s71
    v_exp_f32 v47, v47
    v_exp_f32 v48, v48
    v_exp_f32 v49, v49
    v_exp_f32 v50, v50
    v_exp_f32 v51, v51
    s_cbranch_scc0 L_evd
L_A_mid:
    v_exp_f32 v20, v20
    v_exp_f32 v21, v21
    v_smfmac_f32_32x32x32_bf16 v[216:231], v[172:175], v[44:51], v52
    buffer_load_dwordx4 v[164:167], v144, s[16:19], s66 offen offset:2048 sc1
    v_exp_f32 v22, v22
    v_exp_f32 v23, v23
    v_exp_f32 v24, v24
    v_mfma_f32_32x32x16_bf16 v[36:51], v[176:179], v[12:15], 0
    buffer_load_dwordx4 v[168:171], v145, s[16:19], s66 offen offset:3072 sc1
    v_exp_f32 v25, v25
    v_exp_f32 v26, v26
    v_exp_f32 v27, v27
    v_exp_f32 v28, v28
    v_exp_f32 v29, v29
    v_exp_f32 v30, v30
    v_smfmac_f32_32x32x32_bf16 v[60:75], v[180:183], v[20:27], v52
    buffer_load_dwordx4 v[172:175], v145, s[16:19], s66 offen offset:3584 sc1
    v_exp_f32 v31, v31
    v_exp_f32 v32, v32
    v_exp_f32 v33, v33
    v_exp_f32 v34, v34
    v_exp_f32 v35, v35
    v_exp_f32 v36, v36
    v_exp_f32 v37, v37
    v_smfmac_f32_32x32x32_bf16 v[60:75], v[184:187], v[28:35], v52
    s_add_u32 m0, s39, s15
    v_exp_f32 v38, v38
    v_exp_f32 v39, v39
    v_exp_f32 v40, v40
    v_mfma_f32_32x32x16_bf16 v[20:35], v[176:179], v[232:235], 0
    buffer_load_dwordx4 v7, s[8:11], s38 offen lds
    v_exp_f32 v41, v41
    v_exp_f32 v42, v42
    v_exp_f32 v43, v43
    v_exp_f32 v44, v44
    v_exp_f32 v45, v45
    v_exp_f32 v46, v46
    v_smfmac_f32_32x32x32_bf16 v[76:91], v[180:183], v[36:43], v52
    s_add_u32 m0, m0, s44
    v_exp_f32 v47, v47
    v_exp_f32 v48, v48
    v_exp_f32 v49, v49
    v_exp_f32 v50, v50
    v_exp_f32 v51, v51
    v_exp_f32 v20, v20
    v_exp_f32 v21, v21
    v_smfmac_f32_32x32x32_bf16 v[76:91], v[184:187], v[44:51], v52
    buffer_load_dwordx4 v4, s[8:11], s38 offen lds
    v_exp_f32 v22, v22
    v_exp_f32 v23, v23
    v_exp_f32 v24, v24
    v_mfma_f32_32x32x16_bf16 v[36:51], v[176:179], v[236:239], 0
    s_add_u32 s38, s38, 16384
    v_exp_f32 v25, v25
    v_exp_f32 v26, v26
    v_exp_f32 v27, v27
    v_exp_f32 v28, v28
    v_exp_f32 v29, v29
    v_exp_f32 v30, v30
    v_smfmac_f32_32x32x32_bf16 v[200:215], v[180:183], v[20:27], v52
    s_and_b32 s38, s38, 0x1ffff
    v_exp_f32 v31, v31
    v_exp_f32 v32, v32
    v_exp_f32 v33, v33
    v_exp_f32 v34, v34
    v_exp_f32 v35, v35
    v_exp_f32 v36, v36
    v_exp_f32 v37, v37
    v_smfmac_f32_32x32x32_bf16 v[200:215], v[184:187], v[28:35], v52
    s_waitcnt vmcnt(6)
    v_exp_f32 v38, v38
    v_exp_f32 v39, v39
    v_exp_f32 v40, v40
    v_mfma_f32_32x32x16_bf16 v[20:35], v[188:191], v[8:11], 0
    s_add_u32 s66, s66, 4096
    v_exp_f32 v41, v41
    v_exp_f32 v42, v42
    v_exp_f32 v43, v43
    v_exp_f32 v44, v44
    v_exp_f32 v45, v45
    v_exp_f32 v46, v46
    v_smfmac_f32_32x32x32_bf16 v[216:231], v[180:183], v[36:43], v52
    s_and_b32 s66, s66, 0x1ffff
    v_exp_f32 v47, v47
    v_exp_f32 v48, v48
    v_exp_f32 v49, v49
    v_exp_f32 v50, v50
    v_exp_f32 v51, v51
    v_exp_f32 v20, v20
    v_exp_f32 v21, v21
    v_smfmac_f32_32x32x32_bf16 v[216:231], v[184:187], v[44:51], v52
    buffer_load_dwordx4 v[176:179], v144, s[16:19], s66 offen offset:0 sc1
    v_exp_f32 v22, v22
    v_exp_f32 v23, v23
    v_exp_f32 v24, v24
    v_mfma_f32_32x32x16_bf16 v[36:51], v[188:191], v[12:15], 0
    buffer_load_dwordx4 v[180:183], v145, s[16:19], s66 offen offset:1024 sc1
    v_exp_f32 v25, v25
    v_exp_f32 v26, v26
    v_exp_f32 v27, v27
    v_exp_f32 v28, v28
    v_exp_f32 v29, v29
    v_exp_f32 v30, v30
    v_smfmac_f32_32x32x32_bf16 v[60:75], v[192:195], v[20:27], v52
    buffer_load_dwordx4 v[184:187], v145, s[16:19], s66 offen offset:1536 sc1
    v_exp_f32 v31, v31
    v_exp_f32 v32, v32
    v_exp_f32 v33, v33
    v_exp_f32 v34, v34
    v_exp_f32 v35, v35
    v_exp_f32 v36, v36
    v_exp_f32 v37, v37
    v_smfmac_f32_32x32x32_bf16 v[60:75], v[196:199], v[28:35], v52
    s_add_u32 s15, s15, 2048
    v_exp_f32 v38, v38
    v_exp_f32 v39, v39
    v_exp_f32 v40, v40
    v_mfma_f32_32x32x16_bf16 v[20:35], v[188:191], v[232:235], 0
    v_exp_f32 v41, v41
    v_exp_f32 v42, v42
    v_exp_f32 v43, v43
    v_exp_f32 v44, v44
    v_exp_f32 v45, v45
    v_exp_f32 v46, v46
    v_smfmac_f32_32x32x32_bf16 v[76:91], v[192:195], v[36:43], v52
    s_and_b32 s15, s15, 0x3fff
    v_exp_f32 v47, v47
    v_exp_f32 v48, v48
    v_exp_f32 v49, v49
    v_exp_f32 v50, v50
    v_exp_f32 v51, v51
    v_exp_f32 v20, v20
    v_exp_f32 v21, v21
    v_smfmac_f32_32x32x32_bf16 v[76:91], v[196:199], v[44:51], v52
    v_exp_f32 v22, v22
    v_exp_f32 v23, v23
    v_exp_f32 v24, v24
    v_mfma_f32_32x32x16_bf16 v[36:51], v[188:191], v[236:239], 0
    v_exp_f32 v25, v25
    v_exp_f32 v26, v26
    v_exp_f32 v27, v27
    v_exp_f32 v28, v28
    v_exp_f32 v29, v29
    v_exp_f32 v30, v30
    v_smfmac_f32_32x32x32_bf16 v[200:215], v[192:195], v[20:27], v52
    v_exp_f32 v31, v31
    v_exp_f32 v32, v32
    v_exp_f32 v33, v33
    v_exp_f32 v34, v34
    v_exp_f32 v35, v35
    v_exp_f32 v36, v36
    v_exp_f32 v37, v37
    v_smfmac_f32_32x32x32_bf16 v[200:215], v[196:199], v[28:35], v52
    s_waitcnt vmcnt(6)
    v_exp_f32 v38, v38
    v_exp_f32 v39, v39
    v_exp_f32 v40, v40
    v_mfma_f32_32x32x16_bf16 v[20:35], v[152:155], v[8:11], 0
    s_sub_u32 s67, s67, 1
    v_exp_f32 v41, v41
    v_exp_f32 v42, v42
    v_exp_f32 v43, v43
    v_exp_f32 v44, v44
    v_exp_f32 v45, v45
    v_exp_f32 v46, v46
    v_smfmac_f32_32x32x32_bf16 v[216:231], v[192:195], v[36:43], v52
    s_cmp_gt_i32 s67, s71
    v_exp_f32 v47, v47
    v_exp_f32 v48, v48
    v_exp_f32 v49, v49
    v_exp_f32 v50, v50
    v_exp_f32 v51, v51
    s_cbranch_scc1 L_A_loop
L_evd:
    s_cmp_ge_u32 s70, 5
    s_cbranch_scc1 L_ev5
    s_cmp_ge_u32 s70, 4
    s_cbranch_scc1 L_ev4
    s_cmp_ge_u32 s70, 3
    s_cbranch_scc1 L_ev3
    s_cmp_eq_u32 s70, 2
    s_cbranch_scc1 L_ev2
    v_mov_b32 v250, 163776
    s_mov_b32 s59, 2097152
L_lw_37:
    ds_read_b32 v251, v250 offset:40
    s_waitcnt lgkmcnt(0)
    v_cmp_gt_u32 vcc, 4, v251
    s_cbranch_vccz L_lw_37_ok
    s_sleep 1
    s_sub_u32 s59, s59, 1
    s_cmp_lg_u32 s59, 0
    s_cbranch_scc1 L_lw_37
L_lw_37_ok:
    s_mov_b32 s39, s42
    s_mov_b32 s38, s43
    s_mov_b32 s44, 16384
    s_mov_b32 s15, 0
    s_mov_b32 s70, 3
    s_mov_b32 s71, 4
L_A_ret:
    s_bitcmp1_b32 s67, 0
    s_cbranch_scc0 L_A_mid
    s_branch L_A_loop
L_bmask_24:
    v_mfma_f32_32x32x16_bf16 v[36:51], v[176:179], v[16:19], v[124:139]
    s_branch L_bmask_24_r
L_bmask_25:
    v_mfma_f32_32x32x16_bf16 v[20:35], v[176:179], v[240:243], v[124:139]
    s_branch L_bmask_25_r
L_bmask_26:
    v_mfma_f32_32x32x16_bf16 v[36:51], v[188:191], v[16:19], v[124:139]
    s_branch L_bmask_26_r
L_bmask_27:
    v_mfma_f32_32x32x16_bf16 v[20:35], v[188:191], v[240:243], v[124:139]
    s_branch L_bmask_27_r
L_bmask_28:
    v_mfma_f32_32x32x16_bf16 v[36:51], v[152:155], v[16:19], v[124:139]
    s_branch L_bmask_28_r
L_bmask_29:
    v_mfma_f32_32x32x16_bf16 v[20:35], v[152:155], v[240:243], v[124:139]
    s_branch L_bmask_29_r
L_bmask_30:
    v_mfma_f32_32x32x16_bf16 v[36:51], v[164:167], v[16:19], v[124:139]
    s_branch L_bmask_30_r
L_bmask_31:
    v_mfma_f32_32x32x16_bf16 v[20:35], v[164:167], v[240:243], v[124:139]
    s_branch L_bmask_31_r
L_bmask_32:
    v_mfma_f32_32x32x16_bf16 v[36:51], v[176:179], v[16:19], v[124:139]
    s_branch L_bmask_32_r
L_bmask_33:
    v_mfma_f32_32x32x16_bf16 v[20:35], v[176:179], v[240:243], v[124:139]
    s_branch L_bmask_33_r
L_bmask_34:
    v_mfma_f32_32x32x16_bf16 v[36:51], v[188:191], v[16:19], v[124:139]
    s_branch L_bmask_34_r
L_bmask_35:
    v_mfma_f32_32x32x16_bf16 v[20:35], v[188:191], v[240:243], v[124:139]
    s_branch L_bmask_35_r
L_bmask_36:
    v_mfma_f32_32x32x16_bf16 v[36:51], v[152:155], v[16:19], v[124:139]
    s_branch L_bmask_36_r
L_ev2:
    s_lshl_b32 s59, s57, 8
    s_lshl_b32 s60, s69, 3
    s_add_u32 s59, s59, s60
    s_add_u32 s59, s59, 16809984
    v_lshlrev_b32 v250, 8, v1
    v_mov_b32 v252, s30
    v_mov_b32 v253, s31
    s_mov_b32 s70, 3
    s_mov_b32 s71, 4
    s_waitcnt vmcnt(0)
    s_mov_b64 exec, 3
    buffer_store_dwordx2 v[252:253], v250, s[16:19], s59 offen sc1
    s_mov_b64 exec, -1
    s_branch L_A_ret
L_ev3:
    s_setprio 2
    s_mov_b32 s70, 4
    s_mov_b32 s71, 2
    s_branch L_A_ret
L_ev4:
    s_setprio 1
    v_lshlrev_b32 v250, 1, v6
    s_lshl_b32 s60, s32, 8
    s_add_u32 s60, s60, 16809984
    buffer_load_dwordx2 v[248:249], v250, s[16:19], s60 offen sc1
    s_mov_b32 s70, 5
    s_mov_b32 s71, 0
    s_branch L_A_ret
L_ev5:
    v_smfmac_f32_32x32x32_bf16 v[216:231], v[172:175], v[44:51], v52
    v_mov_b32 v151, 1
    s_cmp_lg_u32 s56, 0
    s_cbranch_scc1 L_lag
    v_mov_b32 v250, 163776
    s_mov_b32 s59, 2097152
L_lw_38:
    ds_read_b32 v251, v250 offset:60
    s_waitcnt lgkmcnt(0)
    v_cmp_gt_u32 vcc, 8, v251
    s_cbranch_vccz L_lw_38_ok
    s_sleep 1
    s_sub_u32 s59, s59, 1
    s_cmp_lg_u32 s59, 0
    s_cbranch_scc1 L_lw_38
L_lw_38_ok:
    ds_write_b128 v141, v[200:203] offset:0
    ds_write_b128 v141, v[204:207] offset:1024
    ds_write_b32 v56, v208 offset:2048
    ds_write_b128 v141, v[216:219] offset:2560
    ds_write_b128 v141, v[220:223] offset:3584
    ds_write_b32 v56, v224 offset:4608
    s_waitcnt lgkmcnt(0)
    s_mov_b64 exec, 1
    ds_add_u32 v147, v151
    s_mov_b64 exec, -1
    s_waitcnt vmcnt(0)
    v_cmp_ne_u64 vcc, s[30:31], v[248:249]
    s_cbranch_vccz L_fok
    s_lshl_b32 s60, s32, 8
    s_add_u32 s60, s60, 16809984
    v_and_b32 v250, 31, v1
    v_lshlrev_b32 v250, 3, v250
    s_mov_b32 s59, 262144
L_poll_39:
    buffer_load_dwordx2 v[252:253], v250, s[16:19], s60 offen sc1
    s_waitcnt vmcnt(0)
    v_cmp_ne_u64 vcc, s[30:31], v[252:253]
    s_cbranch_vccz L_poll_39_ok
    s_sleep 2
    s_sub_u32 s59, s59, 1
    s_cmp_lg_u32 s59, 0
    s_cbranch_scc1 L_poll_39
L_poll_39_ok:
L_fok:
    s_lshl_b32 s63, s14, 20
    s_lshl_b32 s59, s32, 10
    s_add_u32 s63, s63, s59
    s_add_u32 s63, s63, 14680064
    s_add_u32 s59, s12, 0
    s_and_b32 s59, s59, 7
    s_lshl_b32 s59, s59, 16
    s_add_u32 s59, s59, s63
    buffer_load_dwordx4 v[200:203], v2, s[16:19], s59 offen sc1
    s_add_u32 s59, s12, 1
    s_and_b32 s59, s59, 7
    s_lshl_b32 s59, s59, 16
    s_add_u32 s59, s59, s63
    buffer_load_dwordx4 v[204:207], v2, s[16:19], s59 offen sc1
    s_add_u32 s59, s12, 2
    s_and_b32 s59, s59, 7
    s_lshl_b32 s59, s59, 16
    s_add_u32 s59, s59, s63
    buffer_load_dwordx4 v[208:211], v2, s[16:19], s59 offen sc1
    s_add_u32 s59, s12, 3
    s_and_b32 s59, s59, 7
    s_lshl_b32 s59, s59, 16
    s_add_u32 s59, s59, s63
    buffer_load_dwordx4 v[212:215], v2, s[16:19], s59 offen sc1
    s_add_u32 s59, s12, 4
    s_and_b32 s59, s59, 7
    s_lshl_b32 s59, s59, 16
    s_add_u32 s59, s59, s63
    buffer_load_dwordx4 v[216:219], v2, s[16:19], s59 offen sc1
    s_add_u32 s59, s12, 5
    s_and_b32 s59, s59, 7
    s_lshl_b32 s59, s59, 16
    s_add_u32 s59, s59, s63
    buffer_load_dwordx4 v[220:223], v2, s[16:19], s59 offen sc1
    s_add_u32 s59, s12, 6
    s_and_b32 s59, s59, 7
    s_lshl_b32 s59, s59, 16
    s_add_u32 s59, s59, s63
    buffer_load_dwordx4 v[224:227], v2, s[16:19], s59 offen sc1
    s_add_u32 s59, s12, 7
    s_and_b32 s59, s59, 7
    s_lshl_b32 s59, s59, 16
    s_add_u32 s59, s59, s63
    buffer_load_dwordx4 v[228:231], v2, s[16:19], s59 offen sc1
    s_lshl_b32 s63, s14, 20
    s_lshl_b32 s59, s32, 10
    s_add_u32 s63, s63, s59
    s_add_u32 s63, s63, 15204352
    s_add_u32 s59, s12, 0
    s_and_b32 s59, s59, 7
    s_lshl_b32 s59, s59, 16
    s_add_u32 s59, s59, s63
    buffer_load_dwordx4 v[152:155], v2, s[16:19], s59 offen sc1
    s_add_u32 s59, s12, 1
    s_and_b32 s59, s59, 7
    s_lshl_b32 s59, s59, 16
    s_add_u32 s59, s59, s63
    buffer_load_dwordx4 v[156:159], v2, s[16:19], s59 offen sc1
    s_add_u32 s59, s12, 2
    s_and_b32 s59, s59, 7
    s_lshl_b32 s59, s59, 16
    s_add_u32 s59, s59, s63
    buffer_load_dwordx4 v[160:163], v2, s[16:19], s59 offen sc1
    s_add_u32 s59, s12, 3
    s_and_b32 s59, s59, 7
    s_lshl_b32 s59, s59, 16
    s_add_u32 s59, s59, s63
    buffer_load_dwordx4 v[164:167], v2, s[16:19], s59 offen sc1
    s_add_u32 s59, s12, 4
    s_and_b32 s59, s59, 7
    s_lshl_b32 s59, s59, 16
    s_add_u32 s59, s59, s63
    buffer_load_dwordx4 v[168:171], v2, s[16:19], s59 offen sc1
    s_add_u32 s59, s12, 5
    s_and_b32 s59, s59, 7
    s_lshl_b32 s59, s59, 16
    s_add_u32 s59, s59, s63
    buffer_load_dwordx4 v[172:175], v2, s[16:19], s59 offen sc1
    s_add_u32 s59, s12, 6
    s_and_b32 s59, s59, 7
    s_lshl_b32 s59, s59, 16
    s_add_u32 s59, s59, s63
    buffer_load_dwordx4 v[176:179], v2, s[16:19], s59 offen sc1
    s_add_u32 s59, s12, 7
    s_and_b32 s59, s59, 7
    s_lshl_b32 s59, s59, 16
    s_add_u32 s59, s59, s63
    buffer_load_dwordx4 v[180:183], v2, s[16:19], s59 offen sc1
    s_mov_b32 s59, 2097152
L_m0:
    ds_read_b32 v251, v147
    ds_read_b128 v[20:23], v140 offset:0
    ds_read_b128 v[24:27], v140 offset:1024
    ds_read_b32 v28, v55 offset:2048
    ds_read_b128 v[32:35], v140 offset:2560
    ds_read_b128 v[36:39], v140 offset:3584
    ds_read_b32 v40, v55 offset:4608
    s_waitcnt lgkmcnt(6)
    v_cmp_gt_u32 vcc, 2, v251
    s_cbranch_vccz L_m0_ok
    s_sleep 1
    s_sub_u32 s59, s59, 1
    s_cmp_lg_u32 s59, 0
    s_cbranch_scc1 L_m0
L_m0_ok:
    s_waitcnt lgkmcnt(3)
    v_add_f32 v60, v60, v20
    v_add_f32 v61, v61, v21
    v_add_f32 v62, v62, v22
    v_add_f32 v63, v63, v23
    v_add_f32 v64, v64, v24
    v_add_f32 v65, v65, v25
    v_add_f32 v66, v66, v26
    v_add_f32 v67, v67, v27
    v_add_f32 v68, v68, v28
    s_waitcnt lgkmcnt(0)
    v_add_f32 v76, v76, v32
    v_add_f32 v77, v77, v33
    v_add_f32 v78, v78, v34
    v_add_f32 v79, v79, v35
    v_add_f32 v80, v80, v36
    v_add_f32 v81, v81, v37
    v_add_f32 v82, v82, v38
    v_add_f32 v83, v83, v39
    v_add_f32 v84, v84, v40
    ds_write_b128 v140, v[60:63] offset:0
    ds_write_b128 v140, v[64:67] offset:1024
    ds_write_b32 v55, v68 offset:2048
    ds_write_b128 v140, v[76:79] offset:2560
    ds_write_b128 v140, v[80:83] offset:3584
    ds_write_b32 v55, v84 offset:4608
    s_waitcnt lgkmcnt(0)
    s_mov_b64 exec, 1
    ds_add_u32 v147, v151
    s_mov_b64 exec, -1
    s_setprio 0
    v_mov_b32 v250, 163776
    v_mov_b32 v251, 1
    s_mov_b64 exec, 1
    ds_add_u32 v250, v251 offset:12
    s_mov_b64 exec, -1
    v_lshrrev_b32 v102, 5, v1
    v_bfe_u32 v103, v1, 2, 2
    v_lshl_add_u32 v103, v102, 2, v103
    v_lshlrev_b32 v104, 7, v103
    v_and_b32 v103, 1, v1
    v_lshl_add_u32 v104, v103, 4, v104
    v_bfe_u32 v103, v1, 4, 1
    v_lshl_add_u32 v104, v103, 5, v104
    v_bfe_u32 v103, v1, 1, 1
    v_lshl_add_u32 v104, v103, 3, v104
    v_bfe_u32 v103, v1, 3, 1
    v_lshl_add_u32 v104, v103, 6, v104
    s_lshl_b32 s60, s14, 15
    v_add_u32 v92, s60, v104
    v_xor_b32 v93, 64, v92
    s_lshl_b32 s60, s14, 14
    s_add_u32 s60, s60, 0x10000
    v_add_u32 v94, s60, v104
    v_xor_b32 v95, 64, v94
    s_lshl_b32 s60, s13, 2
    s_add_u32 s60, s60, s14
    s_mul_i32 s61, s60, 8448
    s_cmp_eq_u32 s60, 7
    s_cselect_b32 s61, 131072, s61
    v_lshl_add_u32 v96, v102, 5, v2
    v_add_u32 v96, s61, v96
    v_lshrrev_b32 v103, 3, v1
    s_lshl_b32 s60, s14, 3
    v_add_u32 v103, s60, v103
    v_lshlrev_b32 v98, 10, v103
    v_lshlrev_b32 v97, 4, v103
    v_bfe_u32 v103, v1, 1, 2
    v_mul_u32_u24 v103, 2112, v103
    v_add_u32 v97, v97, v103
    v_and_b32 v103, 1, v1
    v_mul_u32_u24 v103, 544, v103
    v_add_u32 v97, v97, v103
    s_mul_i32 s61, s13, 105728
    s_add_u32 s61, s61, 25344
    v_add_u32 v99, s61, v97
    s_mul_i32 s60, s13, 33792
    v_add_u32 v97, s60, v97
    v_and_b32 v103, 0x70, v2
    v_add_u32 v98, v98, v103
    s_lshl_b32 s41, s32, 15
    s_lshl_b32 s60, s12, 7
    s_add_u32 s41, s41, s60
    v_mov_b32 v108, 0
    v_mov_b32 v109, 0
    v_mov_b32 v110, 0
    v_mov_b32 v111, 0
    v_mov_b32 v112, 0
    v_mov_b32 v113, 0
    v_mov_b32 v114, 0
    v_mov_b32 v115, 0
    v_mov_b32 v116, 0
    v_mov_b32 v117, 0
    v_mov_b32 v118, 0
    v_mov_b32 v119, 0
    v_mov_b32 v120, 0
    v_mov_b32 v121, 0
    v_mov_b32 v122, 0
    v_mov_b32 v123, 0
    v_mov_b32 v124, 0
    v_mov_b32 v125, 0
    v_mov_b32 v126, 0
    v_mov_b32 v127, 0
    v_mov_b32 v128, 0
    v_mov_b32 v129, 0
    v_mov_b32 v130, 0
    v_mov_b32 v131, 0
    v_mov_b32 v132, 0
    v_mov_b32 v133, 0
    v_mov_b32 v134, 0
    v_mov_b32 v135, 0
    v_mov_b32 v136, 0
    v_mov_b32 v137, 0
    v_mov_b32 v138, 0
    v_mov_b32 v139, 0
    v_mov_b32 v250, 163776
    s_mov_b32 s59, 2097152
L_lw_40:
    ds_read_b32 v251, v250 offset:12
    s_waitcnt lgkmcnt(0)
    v_cmp_gt_u32 vcc, 4, v251
    s_cbranch_vccz L_lw_40_ok
    s_sleep 1
    s_sub_u32 s59, s59, 1
    s_cmp_lg_u32 s59, 0
    s_cbranch_scc1 L_lw_40
L_lw_40_ok:
    ds_read_b64_tr_b16 v[232:233], v92 offset:0
    ds_read_b64_tr_b16 v[234:235], v92 offset:1024
    ds_read_b64_tr_b16 v[236:237], v93 offset:0
    ds_read_b64_tr_b16 v[238:239], v93 offset:1024
    ds_read_b64_tr_b16 v[240:241], v92 offset:2048
    ds_read_b64_tr_b16 v[242:243], v92 offset:3072
    ds_read_b64_tr_b16 v[244:245], v93 offset:2048
    ds_read_b64_tr_b16 v[246:247], v93 offset:3072
    s_waitcnt vmcnt(15) lgkmcnt(4)
    v_mfma_f32_32x32x16_bf16 v[108:123], v[232:235], v[200:203], v[108:123]
    v_mfma_f32_32x32x16_bf16 v[124:139], v[236:239], v[200:203], v[124:139]
    ds_read_b64_tr_b16 v[232:233], v92 offset:4096
    ds_read_b64_tr_b16 v[234:235], v92 offset:5120
    ds_read_b64_tr_b16 v[236:237], v93 offset:4096
    ds_read_b64_tr_b16 v[238:239], v93 offset:5120
    s_waitcnt vmcnt(14) lgkmcnt(4)
    v_mfma_f32_32x32x16_bf16 v[108:123], v[240:243], v[204:207], v[108:123]
    v_mfma_f32_32x32x16_bf16 v[124:139], v[244:247], v[204:207], v[124:139]
    ds_read_b64_tr_b16 v[240:241], v92 offset:6144
    ds_read_b64_tr_b16 v[242:243], v92 offset:7168
    ds_read_b64_tr_b16 v[244:245], v93 offset:6144
    ds_read_b64_tr_b16 v[246:247], v93 offset:7168
    s_waitcnt vmcnt(13) lgkmcnt(4)
    v_mfma_f32_32x32x16_bf16 v[108:123], v[232:235], v[208:211], v[108:123]
    v_mfma_f32_32x32x16_bf16 v[124:139], v[236:239], v[208:211], v[124:139]
    ds_read_b64_tr_b16 v[232:233], v92 offset:8192
    ds_read_b64_tr_b16 v[234:235], v92 offset:9216
    ds_read_b64_tr_b16 v[236:237], v93 offset:8192
    ds_read_b64_tr_b16 v[238:239], v93 offset:9216
    s_waitcnt vmcnt(12) lgkmcnt(4)
    v_mfma_f32_32x32x16_bf16 v[108:123], v[240:243], v[212:215], v[108:123]
    v_mfma_f32_32x32x16_bf16 v[124:139], v[244:247], v[212:215], v[124:139]
    ds_read_b64_tr_b16 v[240:241], v92 offset:10240
    ds_read_b64_tr_b16 v[242:243], v92 offset:11264
    ds_read_b64_tr_b16 v[244:245], v93 offset:10240
    ds_read_b64_tr_b16 v[246:247], v93 offset:11264
    s_waitcnt vmcnt(11) lgkmcnt(4)
    v_mfma_f32_32x32x16_bf16 v[108:123], v[232:235], v[216:219], v[108:123]
    v_mfma_f32_32x32x16_bf16 v[124:139], v[236:239], v[216:219], v[124:139]
    ds_read_b64_tr_b16 v[232:233], v92 offset:12288
    ds_read_b64_tr_b16 v[234:235], v92 offset:13312
    ds_read_b64_tr_b16 v[236:237], v93 offset:12288
    ds_read_b64_tr_b16 v[238:239], v93 offset:13312
    s_waitcnt vmcnt(10) lgkmcnt(4)
    v_mfma_f32_32x32x16_bf16 v[108:123], v[240:243], v[220:223], v[108:123]
    v_mfma_f32_32x32x16_bf16 v[124:139], v[244:247], v[220:223], v[124:139]
    ds_read_b64_tr_b16 v[240:241], v92 offset:14336
    ds_read_b64_tr_b16 v[242:243], v92 offset:15360
    ds_read_b64_tr_b16 v[244:245], v93 offset:14336
    ds_read_b64_tr_b16 v[246:247], v93 offset:15360
    s_waitcnt vmcnt(9) lgkmcnt(4)
    v_mfma_f32_32x32x16_bf16 v[108:123], v[232:235], v[224:227], v[108:123]
    v_mfma_f32_32x32x16_bf16 v[124:139], v[236:239], v[224:227], v[124:139]
    ds_read_b64_tr_b16 v[232:233], v92 offset:16384
    ds_read_b64_tr_b16 v[234:235], v92 offset:17408
    ds_read_b64_tr_b16 v[236:237], v93 offset:16384
    ds_read_b64_tr_b16 v[238:239], v93 offset:17408
    s_waitcnt vmcnt(8) lgkmcnt(4)
    v_mfma_f32_32x32x16_bf16 v[108:123], v[240:243], v[228:231], v[108:123]
    v_mfma_f32_32x32x16_bf16 v[124:139], v[244:247], v[228:231], v[124:139]
    ds_read_b64_tr_b16 v[240:241], v92 offset:18432
    ds_read_b64_tr_b16 v[242:243], v92 offset:19456
    ds_read_b64_tr_b16 v[244:245], v93 offset:18432
    ds_read_b64_tr_b16 v[246:247], v93 offset:19456
    s_waitcnt vmcnt(7) lgkmcnt(4)
    v_mfma_f32_32x32x16_bf16 v[108:123], v[232:235], v[152:155], v[108:123]
    v_mfma_f32_32x32x16_bf16 v[124:139], v[236:239], v[152:155], v[124:139]
    ds_read_b64_tr_b16 v[232:233], v92 offset:20480
    ds_read_b64_tr_b16 v[234:235], v92 offset:21504
    ds_read_b64_tr_b16 v[236:237], v93 offset:20480
    ds_read_b64_tr_b16 v[238:239], v93 offset:21504
    s_waitcnt vmcnt(6) lgkmcnt(4)
    v_mfma_f32_32x32x16_bf16 v[108:123], v[240:243], v[156:159], v[108:123]
    v_mfma_f32_32x32x16_bf16 v[124:139], v[244:247], v[156:159], v[124:139]
    ds_read_b64_tr_b16 v[240:241], v92 offset:22528
    ds_read_b64_tr_b16 v[242:243], v92 offset:23552
    ds_read_b64_tr_b16 v[244:245], v93 offset:22528
    ds_read_b64_tr_b16 v[246:247], v93 offset:23552
    s_waitcnt vmcnt(5) lgkmcnt(4)
    v_mfma_f32_32x32x16_bf16 v[108:123], v[232:235], v[160:163], v[108:123]
    v_mfma_f32_32x32x16_bf16 v[124:139], v[236:239], v[160:163], v[124:139]
    ds_read_b64_tr_b16 v[232:233], v92 offset:24576
    ds_read_b64_tr_b16 v[234:235], v92 offset:25600
    ds_read_b64_tr_b16 v[236:237], v93 offset:24576
    ds_read_b64_tr_b16 v[238:239], v93 offset:25600
    s_waitcnt vmcnt(4) lgkmcnt(4)
    v_mfma_f32_32x32x16_bf16 v[108:123], v[240:243], v[164:167], v[108:123]
    v_mfma_f32_32x32x16_bf16 v[124:139], v[244:247], v[164:167], v[124:139]
    ds_read_b64_tr_b16 v[240:241], v92 offset:26624
    ds_read_b64_tr_b16 v[242:243], v92 offset:27648
    ds_read_b64_tr_b16 v[244:245], v93 offset:26624
    ds_read_b64_tr_b16 v[246:247], v93 offset:27648
    s_waitcnt vmcnt(3) lgkmcnt(4)
    v_mfma_f32_32x32x16_bf16 v[108:123], v[232:235], v[168:171], v[108:123]
    v_mfma_f32_32x32x16_bf16 v[124:139], v[236:239], v[168:171], v[124:139]
    ds_read_b64_tr_b16 v[232:233], v92 offset:28672
    ds_read_b64_tr_b16 v[234:235], v92 offset:29696
    ds_read_b64_tr_b16 v[236:237], v93 offset:28672
    ds_read_b64_tr_b16 v[238:239], v93 offset:29696
    s_waitcnt vmcnt(2) lgkmcnt(4)
    v_mfma_f32_32x32x16_bf16 v[108:123], v[240:243], v[172:175], v[108:123]
    v_mfma_f32_32x32x16_bf16 v[124:139], v[244:247], v[172:175], v[124:139]
    ds_read_b64_tr_b16 v[240:241], v92 offset:30720
    ds_read_b64_tr_b16 v[242:243], v92 offset:31744
    ds_read_b64_tr_b16 v[244:245], v93 offset:30720
    ds_read_b64_tr_b16 v[246:247], v93 offset:31744
    s_waitcnt vmcnt(1) lgkmcnt(4)
    v_mfma_f32_32x32x16_bf16 v[108:123], v[232:235], v[176:179], v[108:123]
    v_mfma_f32_32x32x16_bf16 v[124:139], v[236:239], v[176:179], v[124:139]
    s_waitcnt vmcnt(0) lgkmcnt(0)
    v_mfma_f32_32x32x16_bf16 v[108:123], v[240:243], v[180:183], v[108:123]
    v_mfma_f32_32x32x16_bf16 v[124:139], v[244:247], v[180:183], v[124:139]
    v_mov_b32 v250, 163776
    v_mov_b32 v251, 1
    s_mov_b64 exec, 1
    ds_add_u32 v250, v251 offset:32
    s_mov_b64 exec, -1
    s_branch L_p3
L_lag:
    s_mov_b32 s59, 2097152
L_m1:
    ds_read_b32 v251, v147
    ds_read_b128 v[20:23], v141 offset:0
    ds_read_b128 v[24:27], v141 offset:1024
    ds_read_b32 v28, v56 offset:2048
    ds_read_b128 v[32:35], v141 offset:2560
    ds_read_b128 v[36:39], v141 offset:3584
    ds_read_b32 v40, v56 offset:4608
    s_waitcnt lgkmcnt(6)
    v_cmp_gt_u32 vcc, 4, v251
    s_cbranch_vccz L_m1_ok
    s_sleep 1
    s_sub_u32 s59, s59, 1
    s_cmp_lg_u32 s59, 0
    s_cbranch_scc1 L_m1
L_m1_ok:
    s_waitcnt lgkmcnt(3)
    v_add_f32 v200, v200, v20
    v_add_f32 v201, v201, v21
    v_add_f32 v202, v202, v22
    v_add_f32 v203, v203, v23
    v_add_f32 v204, v204, v24
    v_add_f32 v205, v205, v25
    v_add_f32 v206, v206, v26
    v_add_f32 v207, v207, v27
    v_add_f32 v208, v208, v28
    s_waitcnt lgkmcnt(0)
    v_add_f32 v216, v216, v32
    v_add_f32 v217, v217, v33
    v_add_f32 v218, v218, v34
    v_add_f32 v219, v219, v35
    v_add_f32 v220, v220, v36
    v_add_f32 v221, v221, v37
    v_add_f32 v222, v222, v38
    v_add_f32 v223, v223, v39
    v_add_f32 v224, v224, v40
    ds_write_b128 v141, v[200:203] offset:0
    ds_write_b128 v141, v[204:207] offset:1024
    ds_write_b32 v56, v208 offset:2048
    ds_write_b128 v141, v[216:219] offset:2560
    ds_write_b128 v141, v[220:223] offset:3584
    ds_write_b32 v56, v224 offset:4608
    s_lshl_b32 s60, s33, 7
    s_add_u32 s60, s60, 154624
    v_add_u32 v148, s60, v6
    ds_read_b32 v53, v148
    ds_read_b32 v54, v148 offset:128
    s_waitcnt lgkmcnt(0)
    s_mov_b64 exec, 1
    ds_add_u32 v147, v151
    s_mov_b64 exec, -1
    s_add_u32 s66, s64, 12582912
    s_add_u32 s40, s66, 1024
    s_mov_b32 s28, 0
    s_mov_b32 s59, 2097152
L_m2:
    ds_read_b32 v251, v147
    ds_read_b128 v[20:23], v140 offset:0
    ds_read_b128 v[24:27], v140 offset:1024
    ds_read_b32 v28, v55 offset:2048
    ds_read_b128 v[32:35], v140 offset:2560
    ds_read_b128 v[36:39], v140 offset:3584
    ds_read_b32 v40, v55 offset:4608
    s_waitcnt lgkmcnt(6)
    v_cmp_gt_u32 vcc, 6, v251
    s_cbranch_vccz L_m2_ok
    s_sleep 1
    s_sub_u32 s59, s59, 1
    s_cmp_lg_u32 s59, 0
    s_cbranch_scc1 L_m2
L_m2_ok:
    s_waitcnt lgkmcnt(3)
    v_add_f32 v60, v60, v20
    v_add_f32 v61, v61, v21
    v_add_f32 v62, v62, v22
    v_add_f32 v63, v63, v23
    v_add_f32 v64, v64, v24
    v_add_f32 v65, v65, v25
    v_add_f32 v66, v66, v26
    v_add_f32 v67, v67, v27
    v_add_f32 v68, v68, v28
    s_waitcnt lgkmcnt(0)
    v_add_f32 v76, v76, v32
    v_add_f32 v77, v77, v33
    v_add_f32 v78, v78, v34
    v_add_f32 v79, v79, v35
    v_add_f32 v80, v80, v36
    v_add_f32 v81, v81, v37
    v_add_f32 v82, v82, v38
    v_add_f32 v83, v83, v39
    v_add_f32 v84, v84, v40
    s_waitcnt vmcnt(0)
L_A0_fin:
    v_rcp_f32 v151, v68
    v_cmp_gt_f32 s[60:61], s26, v68
    v_cmp_lt_f32 vcc, 0x1f800000, v68
    v_mul_f32 v151, v53, v151
    v_mul_f32 v60, v151, v60
    v_mul_f32 v61, v151, v61
    v_mul_f32 v62, v151, v62
    v_mul_f32 v63, v151, v63
    v_mul_f32 v64, v151, v64
    v_mul_f32 v65, v151, v65
    v_mul_f32 v66, v151, v66
    v_mul_f32 v67, v151, v67
    v_add_f32 v5, |v60|, |v61|
    v_add_f32 v5, v5, |v62|
    v_add_f32 v5, v5, |v63|
    v_add_f32 v5, v5, |v64|
    v_add_f32 v5, v5, |v65|
    v_add_f32 v5, v5, |v66|
    v_add_f32 v5, v5, |v67|
    v_cmp_gt_f32 s[62:63], s27, v5
    v_cvt_pk_bf16_f32 v72, v60, v61
    v_cvt_pk_bf16_f32 v73, v62, v63
    v_cvt_pk_bf16_f32 v74, v64, v65
    v_cvt_pk_bf16_f32 v75, v66, v67
    v_min_u32 v72, -2, v72
    v_min_u32 v73, -2, v73
    v_min_u32 v74, -2, v74
    v_min_u32 v75, -2, v75
    s_and_b64 s[60:61], s[60:61], vcc
    s_and_b64 s[60:61], s[60:61], s[62:63]
    s_cmp_eq_u64 s[60:61], -1
    s_cselect_b32 s60, 1, s28
    s_cmp_eq_u32 s60, 0
    s_cbranch_scc1 L_A0_fb
    buffer_store_dwordx4 v[72:75], v2, s[16:19], s66 offen sc1
L_A1_fin:
    v_rcp_f32 v151, v84
    v_cmp_gt_f32 s[60:61], s26, v84
    v_cmp_lt_f32 vcc, 0x1f800000, v84
    v_mul_f32 v151, v54, v151
    v_mul_f32 v76, v151, v76
    v_mul_f32 v77, v151, v77
    v_mul_f32 v78, v151, v78
    v_mul_f32 v79, v151, v79
    v_mul_f32 v80, v151, v80
    v_mul_f32 v81, v151, v81
    v_mul_f32 v82, v151, v82
    v_mul_f32 v83, v151, v83
    v_add_f32 v5, |v76|, |v77|
    v_add_f32 v5, v5, |v78|
    v_add_f32 v5, v5, |v79|
    v_add_f32 v5, v5, |v80|
    v_add_f32 v5, v5, |v81|
    v_add_f32 v5, v5, |v82|
    v_add_f32 v5, v5, |v83|
    v_cmp_gt_f32 s[62:63], s27, v5
    v_cvt_pk_bf16_f32 v88, v76, v77
    v_cvt_pk_bf16_f32 v89, v78, v79
    v_cvt_pk_bf16_f32 v90, v80, v81
    v_cvt_pk_bf16_f32 v91, v82, v83
    v_min_u32 v88, -2, v88
    v_min_u32 v89, -2, v89
    v_min_u32 v90, -2, v90
    v_min_u32 v91, -2, v91
    s_and_b64 s[60:61], s[60:61], vcc
    s_and_b64 s[60:61], s[60:61], s[62:63]
    s_cmp_eq_u64 s[60:61], -1
    s_cselect_b32 s60, 1, s29
    s_cmp_eq_u32 s60, 0
    s_cbranch_scc1 L_A1_fb
    buffer_store_dwordx4 v[88:91], v2, s[16:19], s40 offen sc1
    v_mov_b32 v250, 163776
    v_mov_b32 v251, 1
    s_mov_b64 exec, 1
    ds_add_u32 v250, v251 offset:44
    s_mov_b64 exec, -1
    v_lshrrev_b32 v102, 5, v1
    v_bfe_u32 v103, v1, 2, 2
    v_lshl_add_u32 v103, v102, 2, v103
    v_lshlrev_b32 v104, 7, v103
    v_and_b32 v103, 1, v1
    v_lshl_add_u32 v104, v103, 4, v104
    v_bfe_u32 v103, v1, 4, 1
    v_lshl_add_u32 v104, v103, 5, v104
    v_bfe_u32 v103, v1, 1, 1
    v_lshl_add_u32 v104, v103, 3, v104
    v_bfe_u32 v103, v1, 3, 1
    v_lshl_add_u32 v104, v103, 6, v104
    s_lshl_b32 s60, s14, 15
    v_add_u32 v92, s60, v104
    v_xor_b32 v93, 64, v92
    s_lshl_b32 s60, s14, 14
    s_add_u32 s60, s60, 0x10000
    v_add_u32 v94, s60, v104
    v_xor_b32 v95, 64, v94
    s_lshl_b32 s60, s13, 2
    s_add_u32 s60, s60, s14
    s_mul_i32 s61, s60, 8448
    s_cmp_eq_u32 s60, 7
    s_cselect_b32 s61, 131072, s61
    v_lshl_add_u32 v96, v102, 5, v2
    v_add_u32 v96, s61, v96
    v_lshrrev_b32 v103, 3, v1
    s_lshl_b32 s60, s14, 3
    v_add_u32 v103, s60, v103
    v_lshlrev_b32 v98, 10, v103
    v_lshlrev_b32 v97, 4, v103
    v_bfe_u32 v103, v1, 1, 2
    v_mul_u32_u24 v103, 2112, v103
    v_add_u32 v97, v97, v103
    v_and_b32 v103, 1, v1
    v_mul_u32_u24 v103, 544, v103
    v_add_u32 v97, v97, v103
    s_mul_i32 s61, s13, 105728
    s_add_u32 s61, s61, 25344
    v_add_u32 v99, s61, v97
    s_mul_i32 s60, s13, 33792
    v_add_u32 v97, s60, v97
    v_and_b32 v103, 0x70, v2
    v_add_u32 v98, v98, v103
    s_lshl_b32 s41, s32, 15
    s_lshl_b32 s60, s12, 7
    s_add_u32 s41, s41, s60
    v_mov_b32 v108, 0
    v_mov_b32 v109, 0
    v_mov_b32 v110, 0
    v_mov_b32 v111, 0
    v_mov_b32 v112, 0
    v_mov_b32 v113, 0
    v_mov_b32 v114, 0
    v_mov_b32 v115, 0
    v_mov_b32 v116, 0
    v_mov_b32 v117, 0
    v_mov_b32 v118, 0
    v_mov_b32 v119, 0
    v_mov_b32 v120, 0
    v_mov_b32 v121, 0
    v_mov_b32 v122, 0
    v_mov_b32 v123, 0
    v_mov_b32 v124, 0
    v_mov_b32 v125, 0
    v_mov_b32 v126, 0
    v_mov_b32 v127, 0
    v_mov_b32 v128, 0
    v_mov_b32 v129, 0
    v_mov_b32 v130, 0
    v_mov_b32 v131, 0
    v_mov_b32 v132, 0
    v_mov_b32 v133, 0
    v_mov_b32 v134, 0
    v_mov_b32 v135, 0
    v_mov_b32 v136, 0
    v_mov_b32 v137, 0
    v_mov_b32 v138, 0
    v_mov_b32 v139, 0
    s_lshl_b32 s60, s32, 8
    s_add_u32 s60, s60, 16809984
    v_and_b32 v250, 31, v1
    v_lshlrev_b32 v250, 3, v250
    s_mov_b32 s59, 262144
L_poll_41:
    buffer_load_dwordx2 v[252:253], v250, s[16:19], s60 offen sc1
    s_waitcnt vmcnt(0)
    v_cmp_ne_u64 vcc, s[30:31], v[252:253]
    s_cbranch_vccz L_poll_41_ok
    s_sleep 2
    s_sub_u32 s59, s59, 1
    s_cmp_lg_u32 s59, 0
    s_cbranch_scc1 L_poll_41
L_poll_41_ok:
L_p3:
    v_mov_b32 v250, 163776
    s_mov_b32 s59, 2097152
L_lw_42:
    ds_read_b32 v251, v250 offset:44
    s_waitcnt lgkmcnt(0)
    v_cmp_gt_u32 vcc, 4, v251
    s_cbranch_vccz L_lw_42_ok
    s_sleep 1
    s_sub_u32 s59, s59, 1
    s_cmp_lg_u32 s59, 0
    s_cbranch_scc1 L_lw_42
L_lw_42_ok:
    ds_read_b64_tr_b16 v[152:153], v94 offset:0
    ds_read_b64_tr_b16 v[154:155], v94 offset:1024
    ds_read_b64_tr_b16 v[156:157], v95 offset:0
    ds_read_b64_tr_b16 v[158:159], v95 offset:1024
    ds_read_b64_tr_b16 v[160:161], v94 offset:2048
    ds_read_b64_tr_b16 v[162:163], v94 offset:3072
    ds_read_b64_tr_b16 v[164:165], v95 offset:2048
    ds_read_b64_tr_b16 v[166:167], v95 offset:3072
    ds_read_b64_tr_b16 v[168:169], v94 offset:4096
    ds_read_b64_tr_b16 v[170:171], v94 offset:5120
    ds_read_b64_tr_b16 v[172:173], v95 offset:4096
    ds_read_b64_tr_b16 v[174:175], v95 offset:5120
    ds_read_b64_tr_b16 v[176:177], v94 offset:6144
    ds_read_b64_tr_b16 v[178:179], v94 offset:7168
    ds_read_b64_tr_b16 v[180:181], v95 offset:6144
    ds_read_b64_tr_b16 v[182:183], v95 offset:7168
    ds_read_b64_tr_b16 v[184:185], v94 offset:8192
    ds_read_b64_tr_b16 v[186:187], v94 offset:9216
    ds_read_b64_tr_b16 v[188:189], v95 offset:8192
    ds_read_b64_tr_b16 v[190:191], v95 offset:9216
    ds_read_b64_tr_b16 v[192:193], v94 offset:10240
    ds_read_b64_tr_b16 v[194:195], v94 offset:11264
    ds_read_b64_tr_b16 v[196:197], v95 offset:10240
    ds_read_b64_tr_b16 v[198:199], v95 offset:11264
    ds_read_b64_tr_b16 v[200:201], v94 offset:12288
    ds_read_b64_tr_b16 v[202:203], v94 offset:13312
    ds_read_b64_tr_b16 v[204:205], v95 offset:12288
    ds_read_b64_tr_b16 v[206:207], v95 offset:13312
    ds_read_b64_tr_b16 v[208:209], v94 offset:14336
    ds_read_b64_tr_b16 v[210:211], v94 offset:15360
    ds_read_b64_tr_b16 v[212:213], v95 offset:14336
    ds_read_b64_tr_b16 v[214:215], v95 offset:15360
    s_mov_b32 s62, 262144
    s_lshl_b32 s63, s14, 19
    s_lshl_b32 s59, s32, 10
    s_add_u32 s63, s63, s59
    s_add_u32 s63, s63, 12582912
    v_add_u32 v14, s12, v1
    v_and_b32 v14, 7, v14
    v_lshlrev_b32 v14, 16, v14
    s_mov_b32 s61, 0
L_pr:
    s_mov_b64 exec, 0xff
    buffer_load_dword v15, v14, s[16:19], s63 offen offset:1020 sc1
    s_waitcnt vmcnt(0)
    v_cmp_ne_u32 vcc, -1, v15
    s_mov_b64 exec, -1
    s_sub_u32 s62, s62, 1
    s_cmp_eq_u32 s62, 1
    s_cselect_b32 vcc_lo, 0xff, vcc_lo
    s_andn2_b32 s42, vcc_lo, s61
    s_cbranch_scc0 L_pr
    s_or_b32 s61, s61, s42
    s_bitcmp1_b32 s42, 0
    s_cbranch_scc0 L_prs0
    s_add_u32 s59, s12, 0
    s_and_b32 s59, s59, 7
    s_lshl_b32 s59, s59, 16
    s_add_u32 s59, s59, s63
    buffer_load_dwordx4 v[20:23], v2, s[16:19], s59 offen sc1
L_prs0:
    s_bitcmp1_b32 s42, 1
    s_cbranch_scc0 L_prs1
    s_add_u32 s59, s12, 1
    s_and_b32 s59, s59, 7
    s_lshl_b32 s59, s59, 16
    s_add_u32 s59, s59, s63
    buffer_load_dwordx4 v[24:27], v2, s[16:19], s59 offen sc1
L_prs1:
    s_bitcmp1_b32 s42, 2
    s_cbranch_scc0 L_prs2
    s_add_u32 s59, s12, 2
    s_and_b32 s59, s59, 7
    s_lshl_b32 s59, s59, 16
    s_add_u32 s59, s59, s63
    buffer_load_dwordx4 v[28:31], v2, s[16:19], s59 offen sc1
L_prs2:
    s_bitcmp1_b32 s42, 3
    s_cbranch_scc0 L_prs3
    s_add_u32 s59, s12, 3
    s_and_b32 s59, s59, 7
    s_lshl_b32 s59, s59, 16
    s_add_u32 s59, s59, s63
    buffer_load_dwordx4 v[32:35], v2, s[16:19], s59 offen sc1
L_prs3:
    s_bitcmp1_b32 s42, 4
    s_cbranch_scc0 L_prs4
    s_add_u32 s59, s12, 4
    s_and_b32 s59, s59, 7
    s_lshl_b32 s59, s59, 16
    s_add_u32 s59, s59, s63
    buffer_load_dwordx4 v[36:39], v2, s[16:19], s59 offen sc1
L_prs4:
    s_bitcmp1_b32 s42, 5
    s_cbranch_scc0 L_prs5
    s_add_u32 s59, s12, 5
    s_and_b32 s59, s59, 7
    s_lshl_b32 s59, s59, 16
    s_add_u32 s59, s59, s63
    buffer_load_dwordx4 v[40:43], v2, s[16:19], s59 offen sc1
L_prs5:
    s_bitcmp1_b32 s42, 6
    s_cbranch_scc0 L_prs6
    s_add_u32 s59, s12, 6
    s_and_b32 s59, s59, 7
    s_lshl_b32 s59, s59, 16
    s_add_u32 s59, s59, s63
    buffer_load_dwordx4 v[44:47], v2, s[16:19], s59 offen sc1
L_prs6:
    s_bitcmp1_b32 s42, 7
    s_cbranch_scc0 L_prs7
    s_add_u32 s59, s12, 7
    s_and_b32 s59, s59, 7
    s_lshl_b32 s59, s59, 16
    s_add_u32 s59, s59, s63
    buffer_load_dwordx4 v[48:51], v2, s[16:19], s59 offen sc1
L_prs7:
    s_mov_b64 exec, -1
    s_cmp_lg_u32 s61, 0xff
    s_cbranch_scc1 L_pr
    v_mov_b32 v250, 163776
    s_mov_b32 s59, 2097152
L_lw_43:
    ds_read_b32 v251, v250 offset:32
    s_waitcnt lgkmcnt(0)
    v_cmp_gt_u32 vcc, 4, v251
    s_cbranch_vccz L_lw_43_ok
    s_sleep 1
    s_sub_u32 s59, s59, 1
    s_cmp_lg_u32 s59, 0
    s_cbranch_scc1 L_lw_43
L_lw_43_ok:
    s_bitcmp1_b32 s42, 0
    s_cbranch_scc0 L_oc0
    s_waitcnt vmcnt(0)
L_oc0:
    v_max3_u32 v15, v20, v21, v22
    v_max_u32 v15, v15, v23
    v_cmp_eq_u32 vcc, -1, v15
    s_cbranch_vccnz L_or0
L_og0:
    v_mfma_f32_32x32x16_bf16 v[108:123], v[152:155], v[20:23], v[108:123]
    v_mfma_f32_32x32x16_bf16 v[124:139], v[156:159], v[20:23], v[124:139]
    s_bitcmp1_b32 s42, 1
    s_cbranch_scc0 L_oc1
    s_waitcnt vmcnt(0)
L_oc1:
    v_max3_u32 v15, v24, v25, v26
    v_max_u32 v15, v15, v27
    v_cmp_eq_u32 vcc, -1, v15
    s_cbranch_vccnz L_or1
L_og1:
    v_mfma_f32_32x32x16_bf16 v[108:123], v[160:163], v[24:27], v[108:123]
    v_mfma_f32_32x32x16_bf16 v[124:139], v[164:167], v[24:27], v[124:139]
    s_bitcmp1_b32 s42, 2
    s_cbranch_scc0 L_oc2
    s_waitcnt vmcnt(0)
L_oc2:
    v_max3_u32 v15, v28, v29, v30
    v_max_u32 v15, v15, v31
    v_cmp_eq_u32 vcc, -1, v15
    s_cbranch_vccnz L_or2
L_og2:
    v_mfma_f32_32x32x16_bf16 v[108:123], v[168:171], v[28:31], v[108:123]
    v_mfma_f32_32x32x16_bf16 v[124:139], v[172:175], v[28:31], v[124:139]
    s_bitcmp1_b32 s42, 3
    s_cbranch_scc0 L_oc3
    s_waitcnt vmcnt(0)
L_oc3:
    v_max3_u32 v15, v32, v33, v34
    v_max_u32 v15, v15, v35
    v_cmp_eq_u32 vcc, -1, v15
    s_cbranch_vccnz L_or3
L_og3:
    v_mfma_f32_32x32x16_bf16 v[108:123], v[176:179], v[32:35], v[108:123]
    v_mfma_f32_32x32x16_bf16 v[124:139], v[180:183], v[32:35], v[124:139]
    s_bitcmp1_b32 s42, 4
    s_cbranch_scc0 L_oc4
    s_waitcnt vmcnt(0)
L_oc4:
    v_max3_u32 v15, v36, v37, v38
    v_max_u32 v15, v15, v39
    v_cmp_eq_u32 vcc, -1, v15
    s_cbranch_vccnz L_or4
L_og4:
    v_mfma_f32_32x32x16_bf16 v[108:123], v[184:187], v[36:39], v[108:123]
    v_mfma_f32_32x32x16_bf16 v[124:139], v[188:191], v[36:39], v[124:139]
    s_bitcmp1_b32 s42, 5
    s_cbranch_scc0 L_oc5
    s_waitcnt vmcnt(0)
L_oc5:
    v_max3_u32 v15, v40, v41, v42
    v_max_u32 v15, v15, v43
    v_cmp_eq_u32 vcc, -1, v15
    s_cbranch_vccnz L_or5
L_og5:
    v_mfma_f32_32x32x16_bf16 v[108:123], v[192:195], v[40:43], v[108:123]
    v_mfma_f32_32x32x16_bf16 v[124:139], v[196:199], v[40:43], v[124:139]
    s_bitcmp1_b32 s42, 6
    s_cbranch_scc0 L_oc6
    s_waitcnt vmcnt(0)
L_oc6:
    v_max3_u32 v15, v44, v45, v46
    v_max_u32 v15, v15, v47
    v_cmp_eq_u32 vcc, -1, v15
    s_cbranch_vccnz L_or6
L_og6:
    v_mfma_f32_32x32x16_bf16 v[108:123], v[200:203], v[44:47], v[108:123]
    v_mfma_f32_32x32x16_bf16 v[124:139], v[204:207], v[44:47], v[124:139]
    s_bitcmp1_b32 s42, 7
    s_cbranch_scc0 L_oc7
    s_waitcnt vmcnt(0)
L_oc7:
    v_max3_u32 v15, v48, v49, v50
    v_max_u32 v15, v15, v51
    v_cmp_eq_u32 vcc, -1, v15
    s_cbranch_vccnz L_or7
L_og7:
    v_mfma_f32_32x32x16_bf16 v[108:123], v[208:211], v[48:51], v[108:123]
    v_mfma_f32_32x32x16_bf16 v[124:139], v[212:215], v[48:51], v[124:139]
L_dpe:
    s_nop 10
    ds_write_b128 v96, v[108:111] offset:0
    ds_write_b128 v96, v[112:115] offset:1056
    ds_write_b128 v96, v[116:119] offset:2112
    ds_write_b128 v96, v[120:123] offset:3168
    ds_write_b128 v96, v[124:127] offset:4224
    ds_write_b128 v96, v[128:131] offset:5280
    ds_write_b128 v96, v[132:135] offset:6336
    ds_write_b128 v96, v[136:139] offset:7392
    s_waitcnt lgkmcnt(0)
    s_barrier
    ds_read_b128 v[60:63], v97 offset:0
    ds_read_b128 v[64:67], v97 offset:1056
    ds_read_b128 v[68:71], v97 offset:8448
    ds_read_b128 v[72:75], v97 offset:9504
    ds_read_b128 v[76:79], v97 offset:16896
    ds_read_b128 v[80:83], v97 offset:17952
    ds_read_b128 v[84:87], v99 offset:0
    ds_read_b128 v[88:91], v99 offset:1056
    s_waitcnt lgkmcnt(4)
    v_pk_add_f32 v[60:61], v[60:61], v[68:69]
    v_pk_add_f32 v[62:63], v[62:63], v[70:71]
    v_pk_add_f32 v[64:65], v[64:65], v[72:73]
    v_pk_add_f32 v[66:67], v[66:67], v[74:75]
    s_waitcnt lgkmcnt(2)
    v_pk_add_f32 v[60:61], v[60:61], v[76:77]
    v_pk_add_f32 v[62:63], v[62:63], v[78:79]
    v_pk_add_f32 v[64:65], v[64:65], v[80:81]
    v_pk_add_f32 v[66:67], v[66:67], v[82:83]
    s_waitcnt lgkmcnt(0)
    v_pk_add_f32 v[60:61], v[60:61], v[84:85]
    v_pk_add_f32 v[62:63], v[62:63], v[86:87]
    v_pk_add_f32 v[64:65], v[64:65], v[88:89]
    v_pk_add_f32 v[66:67], v[66:67], v[90:91]
    v_cvt_pk_bf16_f32 v48, v60, v61
    v_cvt_pk_bf16_f32 v49, v62, v63
    v_cvt_pk_bf16_f32 v50, v64, v65
    v_cvt_pk_bf16_f32 v51, v66, v67
    buffer_store_dwordx4 v[48:51], v98, s[4:7], s41 offen sc1
L_end:
    s_endpgm
L_or0:
    s_sub_u32 s62, s62, 1
    s_cmp_lt_i32 s62, 1
    s_cbranch_scc1 L_og0
    s_add_u32 s59, s12, 0
    s_and_b32 s59, s59, 7
    s_lshl_b32 s59, s59, 16
    s_add_u32 s59, s59, s63
    buffer_load_dwordx4 v[20:23], v2, s[16:19], s59 offen sc1
    s_waitcnt vmcnt(0)
    s_branch L_oc0
L_or1:
    s_sub_u32 s62, s62, 1
    s_cmp_lt_i32 s62, 1
    s_cbranch_scc1 L_og1
    s_add_u32 s59, s12, 1
    s_and_b32 s59, s59, 7
    s_lshl_b32 s59, s59, 16
    s_add_u32 s59, s59, s63
    buffer_load_dwordx4 v[24:27], v2, s[16:19], s59 offen sc1
    s_waitcnt vmcnt(0)
    s_branch L_oc1
L_or2:
    s_sub_u32 s62, s62, 1
    s_cmp_lt_i32 s62, 1
    s_cbranch_scc1 L_og2
    s_add_u32 s59, s12, 2
    s_and_b32 s59, s59, 7
    s_lshl_b32 s59, s59, 16
    s_add_u32 s59, s59, s63
    buffer_load_dwordx4 v[28:31], v2, s[16:19], s59 offen sc1
    s_waitcnt vmcnt(0)
    s_branch L_oc2
L_or3:
    s_sub_u32 s62, s62, 1
    s_cmp_lt_i32 s62, 1
    s_cbranch_scc1 L_og3
    s_add_u32 s59, s12, 3
    s_and_b32 s59, s59, 7
    s_lshl_b32 s59, s59, 16
    s_add_u32 s59, s59, s63
    buffer_load_dwordx4 v[32:35], v2, s[16:19], s59 offen sc1
    s_waitcnt vmcnt(0)
    s_branch L_oc3
L_or4:
    s_sub_u32 s62, s62, 1
    s_cmp_lt_i32 s62, 1
    s_cbranch_scc1 L_og4
    s_add_u32 s59, s12, 4
    s_and_b32 s59, s59, 7
    s_lshl_b32 s59, s59, 16
    s_add_u32 s59, s59, s63
    buffer_load_dwordx4 v[36:39], v2, s[16:19], s59 offen sc1
    s_waitcnt vmcnt(0)
    s_branch L_oc4
L_or5:
    s_sub_u32 s62, s62, 1
    s_cmp_lt_i32 s62, 1
    s_cbranch_scc1 L_og5
    s_add_u32 s59, s12, 5
    s_and_b32 s59, s59, 7
    s_lshl_b32 s59, s59, 16
    s_add_u32 s59, s59, s63
    buffer_load_dwordx4 v[40:43], v2, s[16:19], s59 offen sc1
    s_waitcnt vmcnt(0)
    s_branch L_oc5
L_or6:
    s_sub_u32 s62, s62, 1
    s_cmp_lt_i32 s62, 1
    s_cbranch_scc1 L_og6
    s_add_u32 s59, s12, 6
    s_and_b32 s59, s59, 7
    s_lshl_b32 s59, s59, 16
    s_add_u32 s59, s59, s63
    buffer_load_dwordx4 v[44:47], v2, s[16:19], s59 offen sc1
    s_waitcnt vmcnt(0)
    s_branch L_oc6
L_or7:
    s_sub_u32 s62, s62, 1
    s_cmp_lt_i32 s62, 1
    s_cbranch_scc1 L_og7
    s_add_u32 s59, s12, 7
    s_and_b32 s59, s59, 7
    s_lshl_b32 s59, s59, 16
    s_add_u32 s59, s59, s63
    buffer_load_dwordx4 v[48:51], v2, s[16:19], s59 offen sc1
    s_waitcnt vmcnt(0)
    s_branch L_oc7
L_A0_fb:
    s_mov_b32 s28, 1
    v_mov_b32 v148, v146
    s_mov_b32 s63, 0
L_A0_pass:
    s_mov_b32 s61, 0
L_A0_tile:
    s_lshl_b32 s62, s61, 11
    buffer_load_dwordx4 v[152:155], v144, s[16:19], s62 offen offset:0 sc1
    buffer_load_dwordx4 v[156:159], v145, s[16:19], s62 offen offset:1024 sc1
    buffer_load_dwordx4 v[160:163], v145, s[16:19], s62 offen offset:1536 sc1
    s_waitcnt vmcnt(0)
    v_mfma_f32_32x32x16_bf16 v[20:35], v[152:155], v[8:11], 0
    s_nop 15
    s_cmp_lg_u32 s63, 0
    s_cbranch_scc1 L_A0_p1
    v_max3_f32 v148, v20, v21, v148
    v_max3_f32 v148, v22, v23, v148
    v_max3_f32 v148, v24, v25, v148
    v_max3_f32 v148, v26, v27, v148
    v_max3_f32 v148, v28, v29, v148
    v_max3_f32 v148, v30, v31, v148
    v_max3_f32 v148, v32, v33, v148
    v_max3_f32 v148, v34, v35, v148
    s_branch L_A0_nx
L_A0_p1:
    v_sub_f32 v20, v20, v148
    v_sub_f32 v21, v21, v148
    v_sub_f32 v22, v22, v148
    v_sub_f32 v23, v23, v148
    v_sub_f32 v24, v24, v148
    v_sub_f32 v25, v25, v148
    v_sub_f32 v26, v26, v148
    v_sub_f32 v27, v27, v148
    v_sub_f32 v28, v28, v148
    v_sub_f32 v29, v29, v148
    v_sub_f32 v30, v30, v148
    v_sub_f32 v31, v31, v148
    v_sub_f32 v32, v32, v148
    v_sub_f32 v33, v33, v148
    v_sub_f32 v34, v34, v148
    v_sub_f32 v35, v35, v148
    v_exp_f32 v20, v20
    v_exp_f32 v21, v21
    v_exp_f32 v22, v22
    v_exp_f32 v23, v23
    v_exp_f32 v24, v24
    v_exp_f32 v25, v25
    v_exp_f32 v26, v26
    v_exp_f32 v27, v27
    v_exp_f32 v28, v28
    v_exp_f32 v29, v29
    v_exp_f32 v30, v30
    v_exp_f32 v31, v31
    v_exp_f32 v32, v32
    v_exp_f32 v33, v33
    v_exp_f32 v34, v34
    v_exp_f32 v35, v35
    s_nop 1
    v_smfmac_f32_32x32x32_bf16 v[60:75], v[156:159], v[20:27], v52
    v_smfmac_f32_32x32x32_bf16 v[60:75], v[160:163], v[28:35], v52
    s_nop 15
L_A0_nx:
    s_add_u32 s61, s61, 1
    s_cmp_lt_u32 s61, 64
    s_cbranch_scc1 L_A0_tile
    s_cmp_lg_u32 s63, 0
    s_cbranch_scc1 L_A0_fin
    v_mov_b32 v151, v148
    s_nop 1
    v_permlane32_swap_b32 v148, v151
    s_nop 1
    v_max_f32 v148, v148, v151
    v_mov_b32 v60, 0
    v_mov_b32 v61, 0
    v_mov_b32 v62, 0
    v_mov_b32 v63, 0
    v_mov_b32 v64, 0
    v_mov_b32 v65, 0
    v_mov_b32 v66, 0
    v_mov_b32 v67, 0
    v_mov_b32 v68, 0
    v_mov_b32 v69, 0
    v_mov_b32 v70, 0
    v_mov_b32 v71, 0
    v_mov_b32 v72, 0
    v_mov_b32 v73, 0
    v_mov_b32 v74, 0
    v_mov_b32 v75, 0
    s_mov_b32 s63, 1
    s_branch L_A0_pass
L_A1_fb:
    s_mov_b32 s29, 1
    v_mov_b32 v148, v146
    s_mov_b32 s63, 0
L_A1_pass:
    s_mov_b32 s61, 0
L_A1_tile:
    s_lshl_b32 s62, s61, 11
    buffer_load_dwordx4 v[152:155], v144, s[16:19], s62 offen offset:0 sc1
    buffer_load_dwordx4 v[156:159], v145, s[16:19], s62 offen offset:1024 sc1
    buffer_load_dwordx4 v[160:163], v145, s[16:19], s62 offen offset:1536 sc1
    s_waitcnt vmcnt(0)
    v_mfma_f32_32x32x16_bf16 v[20:35], v[152:155], v[12:15], 0
    s_nop 15
    s_cmp_lg_u32 s63, 0
    s_cbranch_scc1 L_A1_p1
    v_max3_f32 v148, v20, v21, v148
    v_max3_f32 v148, v22, v23, v148
    v_max3_f32 v148, v24, v25, v148
    v_max3_f32 v148, v26, v27, v148
    v_max3_f32 v148, v28, v29, v148
    v_max3_f32 v148, v30, v31, v148
    v_max3_f32 v148, v32, v33, v148
    v_max3_f32 v148, v34, v35, v148
    s_branch L_A1_nx
L_A1_p1:
    v_sub_f32 v20, v20, v148
    v_sub_f32 v21, v21, v148
    v_sub_f32 v22, v22, v148
    v_sub_f32 v23, v23, v148
    v_sub_f32 v24, v24, v148
    v_sub_f32 v25, v25, v148
    v_sub_f32 v26, v26, v148
    v_sub_f32 v27, v27, v148
    v_sub_f32 v28, v28, v148
    v_sub_f32 v29, v29, v148
    v_sub_f32 v30, v30, v148
    v_sub_f32 v31, v31, v148
    v_sub_f32 v32, v32, v148
    v_sub_f32 v33, v33, v148
    v_sub_f32 v34, v34, v148
    v_sub_f32 v35, v35, v148
    v_exp_f32 v20, v20
    v_exp_f32 v21, v21
    v_exp_f32 v22, v22
    v_exp_f32 v23, v23
    v_exp_f32 v24, v24
    v_exp_f32 v25, v25
    v_exp_f32 v26, v26
    v_exp_f32 v27, v27
    v_exp_f32 v28, v28
    v_exp_f32 v29, v29
    v_exp_f32 v30, v30
    v_exp_f32 v31, v31
    v_exp_f32 v32, v32
    v_exp_f32 v33, v33
    v_exp_f32 v34, v34
    v_exp_f32 v35, v35
    s_nop 1
    v_smfmac_f32_32x32x32_bf16 v[76:91], v[156:159], v[20:27], v52
    v_smfmac_f32_32x32x32_bf16 v[76:91], v[160:163], v[28:35], v52
    s_nop 15
L_A1_nx:
    s_add_u32 s61, s61, 1
    s_cmp_lt_u32 s61, 64
    s_cbranch_scc1 L_A1_tile
    s_cmp_lg_u32 s63, 0
    s_cbranch_scc1 L_A1_fin
    v_mov_b32 v151, v148
    s_nop 1
    v_permlane32_swap_b32 v148, v151
    s_nop 1
    v_max_f32 v148, v148, v151
    v_mov_b32 v76, 0
    v_mov_b32 v77, 0
    v_mov_b32 v78, 0
    v_mov_b32 v79, 0
    v_mov_b32 v80, 0
    v_mov_b32 v81, 0
    v_mov_b32 v82, 0
    v_mov_b32 v83, 0
    v_mov_b32 v84, 0
    v_mov_b32 v85, 0
    v_mov_b32 v86, 0
    v_mov_b32 v87, 0
    v_mov_b32 v88, 0
    v_mov_b32 v89, 0
    v_mov_b32 v90, 0
    v_mov_b32 v91, 0
    s_mov_b32 s63, 1
    s_branch L_A1_pass
L_B0_fb:
    s_mov_b32 s28, 1
    v_mov_b32 v148, v146
    s_mov_b32 s63, 0
L_B0_pass:
    s_sub_i32 s61, s58, 8
    s_max_i32 s61, s61, 0
L_B0_tile:
    s_lshl_b32 s62, s61, 11
    buffer_load_dwordx4 v[188:191], v149, s[16:19], s62 offen offset:0 sc1
    buffer_load_dwordx4 v[192:195], v150, s[16:19], s62 offen offset:1024 sc1
    buffer_load_dwordx4 v[196:199], v150, s[16:19], s62 offen offset:1536 sc1
    s_waitcnt vmcnt(0)
    s_cmp_eq_u32 s61, s58
    s_cbranch_scc1 L_B0_dg
    s_add_u32 s60, s61, 8
    s_cmp_eq_u32 s60, s58
    s_cbranch_scc1 L_B0_fr
    v_mfma_f32_32x32x16_bf16 v[20:35], v[188:191], v[16:19], 0
    s_branch L_B0_s
L_B0_dg:
    v_mfma_f32_32x32x16_bf16 v[20:35], v[188:191], v[16:19], v[108:123]
    s_branch L_B0_s
L_B0_fr:
    v_mfma_f32_32x32x16_bf16 v[20:35], v[188:191], v[16:19], v[124:139]
L_B0_s:
    s_nop 15
    s_cmp_lg_u32 s63, 0
    s_cbranch_scc1 L_B0_p1
    v_max3_f32 v148, v20, v21, v148
    v_max3_f32 v148, v22, v23, v148
    v_max3_f32 v148, v24, v25, v148
    v_max3_f32 v148, v26, v27, v148
    v_max3_f32 v148, v28, v29, v148
    v_max3_f32 v148, v30, v31, v148
    v_max3_f32 v148, v32, v33, v148
    v_max3_f32 v148, v34, v35, v148
    s_branch L_B0_nx
L_B0_p1:
    v_sub_f32 v20, v20, v148
    v_sub_f32 v21, v21, v148
    v_sub_f32 v22, v22, v148
    v_sub_f32 v23, v23, v148
    v_sub_f32 v24, v24, v148
    v_sub_f32 v25, v25, v148
    v_sub_f32 v26, v26, v148
    v_sub_f32 v27, v27, v148
    v_sub_f32 v28, v28, v148
    v_sub_f32 v29, v29, v148
    v_sub_f32 v30, v30, v148
    v_sub_f32 v31, v31, v148
    v_sub_f32 v32, v32, v148
    v_sub_f32 v33, v33, v148
    v_sub_f32 v34, v34, v148
    v_sub_f32 v35, v35, v148
    v_exp_f32 v20, v20
    v_exp_f32 v21, v21
    v_exp_f32 v22, v22
    v_exp_f32 v23, v23
    v_exp_f32 v24, v24
    v_exp_f32 v25, v25
    v_exp_f32 v26, v26
    v_exp_f32 v27, v27
    v_exp_f32 v28, v28
    v_exp_f32 v29, v29
    v_exp_f32 v30, v30
    v_exp_f32 v31, v31
    v_exp_f32 v32, v32
    v_exp_f32 v33, v33
    v_exp_f32 v34, v34
    v_exp_f32 v35, v35
    s_nop 1
    v_smfmac_f32_32x32x32_bf16 v[60:75], v[192:195], v[20:27], v52
    v_smfmac_f32_32x32x32_bf16 v[60:75], v[196:199], v[28:35], v52
    s_nop 15
L_B0_nx:
    s_add_u32 s61, s61, 1
    s_cmp_le_u32 s61, s58
    s_cbranch_scc1 L_B0_tile
    s_cmp_lg_u32 s63, 0
    s_cbranch_scc1 L_B0_fin
    v_mov_b32 v151, v148
    s_nop 1
    v_permlane32_swap_b32 v148, v151
    s_nop 1
    v_max_f32 v148, v148, v151
    v_mov_b32 v60, 0
    v_mov_b32 v61, 0
    v_mov_b32 v62, 0
    v_mov_b32 v63, 0
    v_mov_b32 v64, 0
    v_mov_b32 v65, 0
    v_mov_b32 v66, 0
    v_mov_b32 v67, 0
    v_mov_b32 v68, 0
    v_mov_b32 v69, 0
    v_mov_b32 v70, 0
    v_mov_b32 v71, 0
    v_mov_b32 v72, 0
    v_mov_b32 v73, 0
    v_mov_b32 v74, 0
    v_mov_b32 v75, 0
    s_mov_b32 s63, 1
    s_branch L_B0_pass
L_B1_fb:
    s_mov_b32 s29, 1
    v_mov_b32 v148, v146
    s_mov_b32 s63, 0
L_B1_pass:
    s_sub_i32 s61, s58, 8
    s_max_i32 s61, s61, 0
L_B1_tile:
    s_lshl_b32 s62, s61, 11
    buffer_load_dwordx4 v[188:191], v149, s[16:19], s62 offen offset:0 sc1
    buffer_load_dwordx4 v[192:195], v150, s[16:19], s62 offen offset:1024 sc1
    buffer_load_dwordx4 v[196:199], v150, s[16:19], s62 offen offset:1536 sc1
    s_waitcnt vmcnt(0)
    s_cmp_eq_u32 s61, s58
    s_cbranch_scc1 L_B1_dg
    s_add_u32 s60, s61, 8
    s_cmp_eq_u32 s60, s58
    s_cbranch_scc1 L_B1_fr
    v_mfma_f32_32x32x16_bf16 v[20:35], v[188:191], v[240:243], 0
    s_branch L_B1_s
L_B1_dg:
    v_mfma_f32_32x32x16_bf16 v[20:35], v[188:191], v[240:243], v[108:123]
    s_branch L_B1_s
L_B1_fr:
    v_mfma_f32_32x32x16_bf16 v[20:35], v[188:191], v[240:243], v[124:139]
L_B1_s:
    s_nop 15
    s_cmp_lg_u32 s63, 0
    s_cbranch_scc1 L_B1_p1
    v_max3_f32 v148, v20, v21, v148
    v_max3_f32 v148, v22, v23, v148
    v_max3_f32 v148, v24, v25, v148
    v_max3_f32 v148, v26, v27, v148
    v_max3_f32 v148, v28, v29, v148
    v_max3_f32 v148, v30, v31, v148
    v_max3_f32 v148, v32, v33, v148
    v_max3_f32 v148, v34, v35, v148
    s_branch L_B1_nx
L_B1_p1:
    v_sub_f32 v20, v20, v148
    v_sub_f32 v21, v21, v148
    v_sub_f32 v22, v22, v148
    v_sub_f32 v23, v23, v148
    v_sub_f32 v24, v24, v148
    v_sub_f32 v25, v25, v148
    v_sub_f32 v26, v26, v148
    v_sub_f32 v27, v27, v148
    v_sub_f32 v28, v28, v148
    v_sub_f32 v29, v29, v148
    v_sub_f32 v30, v30, v148
    v_sub_f32 v31, v31, v148
    v_sub_f32 v32, v32, v148
    v_sub_f32 v33, v33, v148
    v_sub_f32 v34, v34, v148
    v_sub_f32 v35, v35, v148
    v_exp_f32 v20, v20
    v_exp_f32 v21, v21
    v_exp_f32 v22, v22
    v_exp_f32 v23, v23
    v_exp_f32 v24, v24
    v_exp_f32 v25, v25
    v_exp_f32 v26, v26
    v_exp_f32 v27, v27
    v_exp_f32 v28, v28
    v_exp_f32 v29, v29
    v_exp_f32 v30, v30
    v_exp_f32 v31, v31
    v_exp_f32 v32, v32
    v_exp_f32 v33, v33
    v_exp_f32 v34, v34
    v_exp_f32 v35, v35
    s_nop 1
    v_smfmac_f32_32x32x32_bf16 v[76:91], v[192:195], v[20:27], v52
    v_smfmac_f32_32x32x32_bf16 v[76:91], v[196:199], v[28:35], v52
    s_nop 15
L_B1_nx:
    s_add_u32 s61, s61, 1
    s_cmp_le_u32 s61, s58
    s_cbranch_scc1 L_B1_tile
    s_cmp_lg_u32 s63, 0
    s_cbranch_scc1 L_B1_fin
    v_mov_b32 v151, v148
    s_nop 1
    v_permlane32_swap_b32 v148, v151
    s_nop 1
    v_max_f32 v148, v148, v151
    v_mov_b32 v76, 0
    v_mov_b32 v77, 0
    v_mov_b32 v78, 0
    v_mov_b32 v79, 0
    v_mov_b32 v80, 0
    v_mov_b32 v81, 0
    v_mov_b32 v82, 0
    v_mov_b32 v83, 0
    v_mov_b32 v84, 0
    v_mov_b32 v85, 0
    v_mov_b32 v86, 0
    v_mov_b32 v87, 0
    v_mov_b32 v88, 0
    v_mov_b32 v89, 0
    v_mov_b32 v90, 0
    v_mov_b32 v91, 0
    s_mov_b32 s63, 1
    s_branch L_B1_pass
L_code_end:
.section .rodata,"a"
.p2align 6
.amdhsa_kernel gated_mix__mha_block__sliding_block__prompt_kernel
  .amdhsa_next_free_vgpr 256
  .amdhsa_next_free_sgpr 102
  .amdhsa_accum_offset 256
  .amdhsa_group_segment_fixed_size 0
  .amdhsa_kernarg_size 80
  .amdhsa_user_sgpr_count 2
  .amdhsa_user_sgpr_kernarg_segment_ptr 1
  .amdhsa_system_sgpr_workgroup_id_x 1
.end_amdhsa_kernel
```
